```python
import torch

def _softmax(x, axis=-1):
    return torch.softmax(x, dim=axis)
def _gelu(x):
    return torch.nn.functional.gelu(x, approximate="tanh")
def _silu(x):
    return torch.nn.functional.silu(x)
def _sigmoid(x):
    return torch.sigmoid(x)
def _layernorm(x, axis=-1, eps=1e-5):
    m = x.mean(dim=axis, keepdim=True)
    v = x.var(dim=axis, keepdim=True, unbiased=False)
    return (x - m) / torch.sqrt(v + eps)
def _scatter_add(tgt, idx, src, axis=0):
    return tgt.clone().index_add_(axis, idx, src)
def _segment_sum(src, seg, n):
    out = torch.zeros((n,) + src.shape[1:], dtype=src.dtype)
    return out.index_add_(0, seg, src)
def _pad(x, pw):
    flat = tuple(v for pair in reversed(pw) for v in pair)
    return torch.nn.functional.pad(x, flat)

kernel_name = 'concat_heads__sliding_block__ssm_conv_h3__prompt'

def setup_inputs():

    _w = (lambda a: (lambda t: t.to(torch.bfloat16) if t.is_floating_point() else t)(torch.as_tensor(a)))
    def _A_setup():
        B, S, D = 1, 2048, 512
        return {
            "x": _w((lambda *s: torch.randn(*s, dtype=torch.bfloat16) * 0.4)(B, S, D)),
            "wqkv": _w((lambda *s: torch.randn(*s, dtype=torch.bfloat16) * 0.4)(D, 3 * D)),
            "wo": _w((lambda *s: torch.randn(*s, dtype=torch.bfloat16) * 0.05)(D, D)),
        }
    _A_in = _A_setup()

    def _B_setup():
        B, S, D = 1, 2048, 512
        ks = 4
        return {
            "q": _w((lambda *s: torch.randn(*s, dtype=torch.bfloat16) * 0.05)(B, S, D)),
            "k": _w((lambda *s: torch.randn(*s, dtype=torch.bfloat16) * 1.6)(B, S, D)),
            "v": _w((lambda *s: torch.randn(*s, dtype=torch.bfloat16) * 1.6)(B, S, D)),
            "shift_k": _w((lambda *s: torch.randn(*s, dtype=torch.bfloat16) * 1.6)(D, ks) * 0.5),
            "ssm_k": _w((lambda *s: torch.randn(*s, dtype=torch.bfloat16) * 3.2)(D, S) * (1.0 / S ** 0.5)),
            "ssm_D": _w((lambda *s: torch.randn(*s, dtype=torch.bfloat16) * 1.6)(D)),
        }
    _B_in = _B_setup()

    return {
        "A_x": _A_in["x"],
        "A_wqkv": _A_in["wqkv"],
        "A_wo": _A_in["wo"],
        "B_q": _B_in["q"],
        "B_k": _B_in["k"],
        "B_v": _B_in["v"],
        "B_shift_k": _B_in["shift_k"],
        "B_ssm_k": _B_in["ssm_k"],
        "B_ssm_D": _B_in["ssm_D"],
    }

def reference(A_x, A_wqkv, A_wo, B_q, B_k, B_v, B_shift_k, B_ssm_k, B_ssm_D):
    def _A_ref(x, wqkv, wo):
        B, S, D = x.shape
        H = 32; Dh = D // H; W = 256
        qkv = (lambda x, *d: x.permute(*d))((x @ wqkv).reshape(B, S, 3, H, Dh), 2, 0, 3, 1, 4)
        q, k, v = qkv[0], qkv[1], qkv[2]
        scores = torch.einsum("bhqd,bhkd->bhqk", q, k) * (Dh ** -0.5)
        idx = torch.arange(S)
        mask = (idx[:, None] - idx[None, :] >= 0) & (idx[:, None] - idx[None, :] < W)
        scores = torch.where(mask[None, None], scores, -1e9)
        p = _softmax(scores, axis=-1)
        o = torch.einsum("bhqk,bhkd->bhqd", p, v)
        return (lambda x, *d: x.permute(*d))(o, 0, 2, 1, 3).reshape(B, S, D) @ wo

    def _B_ref(q, k, v, shift_k, ssm_k, ssm_D):
        B, S, D = q.shape
        ks = shift_k.shape[-1]
        k_pad = _pad(k, ((0, 0), (ks - 1, 0), (0, 0)))
        k_shift = torch.zeros_like(k)
        for t in range(ks):
            k_shift = k_shift + k_pad[:, t:t + S, :] * shift_k[:, ks - 1 - t][None, None, :]
        kv = k_shift * v
        L = 2 * S
        kv_pad = _pad(kv, ((0, 0), (0, S), (0, 0)))
        kf_pad = _pad(ssm_k, ((0, 0), (0, S)))
        kv_f = (lambda x, axes=(-2,-1): torch.fft.rfft2(x.float(), dim=axes))(kv_pad[:, None, :, :], axes=(1, 2))
        kf_f = (lambda x, axes=(-2,-1): torch.fft.rfft2(x.float(), dim=axes))(kf_pad[:, None, :], axes=(1, 2))
        kf_f = (lambda x, *d: x.permute(*d))(kf_f, 1, 2, 0)
        y_f = kv_f * kf_f[None, :, :, :]
        y = (lambda x, s, axes=(-2,-1): torch.fft.irfft2(x, s=s, dim=axes).to(torch.bfloat16))(y_f, (1, L), axes=(1, 2))[:, 0, :S, :]
        y = y + kv * ssm_D[None, None, :]
        return q * y

    a = _A_ref(A_x, A_wqkv, A_wo)
    b = _B_ref(B_q, B_k, B_v, B_shift_k, B_ssm_k, B_ssm_D)
    return torch.concatenate([a, b], axis=-1)
```

```asm
; @launch grid=(256,1,1) block=(512,1,1) lds=163840
.amdgcn_target "amdgcn-amd-amdhsa--gfx950"
.text
.globl concat_heads__sliding_block__ssm_conv_h3__prompt_kernel
.p2align 8
.type concat_heads__sliding_block__ssm_conv_h3__prompt_kernel,@function
concat_heads__sliding_block__ssm_conv_h3__prompt_kernel:
  s_load_dwordx16 s[16:31], s[0:1], 0
  s_load_dwordx8 s[32:39], s[0:1], 64
  s_cmp_ge_u32 s2, 256
  s_cbranch_scc1 L_end
  v_and_b32 v1, 63, v0
  v_lshrrev_b32 v2, 6, v0
  s_and_b32 s63, s2, 7
  s_lshr_b32 s62, s2, 3
  v_readfirstlane_b32 s61, v2
  s_lshr_b32 s66, s63, 1
  s_lshr_b32 s67, s66, 1
  s_xor_b32 s66, s66, s67
  s_lshl_b32 s66, s66, 2
  s_and_b32 s67, s62, 3
  s_add_u32 s64, s66, s67
  s_and_b32 s66, s63, 1
  s_lshl_b32 s66, s66, 3
  s_lshr_b32 s67, s62, 2
  s_add_u32 s65, s66, s67
  s_and_b32 s72, s61, 3
  v_and_b32 v3, 31, v1
  v_lshrrev_b32 v4, 5, v1
  s_cmp_ge_u32 s61, 4
  s_cbranch_scc1 L_lwave
  v_lshrrev_b32 v5, 3, v1
  v_and_b32 v6, 7, v1
  v_lshlrev_b32 v6, 4, v6
  s_lshl_b32 s66, s62, 6
  s_lshl_b32 s67, s61, 4
  s_add_u32 s66, s66, s67
  v_add_u32 v5, s66, v5
  v_lshlrev_b32 v5, 10, v5
  s_lshl_b32 s67, s63, 7
  v_add3_u32 v7, v5, v6, s67
  v_add_u32 v8, 0xffffe000, v7
  v_add_u32 v9, 0x2000, v7
  s_mul_i32 s70, s61, 5120
  s_add_u32 s70, s70, 140416
  s_lshl_b32 s66, s63, 9
  v_lshlrev_b32 v11, 4, v3
  v_add_u32 v11, s66, v11
  s_waitcnt lgkmcnt(0)
  s_mov_b32 s48, s24
  s_and_b32 s49, s25, 0xffff
  s_mov_b32 s50, 2097152
  s_mov_b32 s51, 0x00020000
  s_mov_b32 s40, s26
  s_and_b32 s41, s27, 0xffff
  s_mov_b32 s42, 2097152
  s_mov_b32 s43, 0x00020000
  s_load_dword s60, s[38:39], 131072
  s_add_u32 m0, s70, 0
  s_nop 0
  buffer_load_dwordx4 v8, s[48:51], 0 offen  lds
  s_add_u32 m0, s70, 1024
  s_nop 0
  buffer_load_dwordx4 v7, s[48:51], 0 offen  lds
  s_add_u32 m0, s70, 2048
  s_nop 0
  buffer_load_dwordx4 v9, s[48:51], 0 offen  lds
  s_add_u32 m0, s70, 3072
  s_nop 0
  buffer_load_dwordx4 v7, s[40:43], 0 offen  lds
  s_add_u32 m0, s70, 4096
  s_nop 0
  buffer_load_dwordx4 v9, s[40:43], 0 offen  lds
  global_load_dwordx4 v[36:39], v11, s[28:29]
  s_lshl_b32 s66, s72, 5
  v_add_u32 v110, s66, v3
  v_lshrrev_b32 v111, 1, v110
  v_and_b32 v111, 7, v111
  v_xor_b32 v111, v111, v4
  v_lshlrev_b32 v111, 4, v111
  v_lshl_add_u32 v111, v110, 7, v111
  v_xor_b32 v144, 0, v111
  v_add_u32 v148, 57344, v144
  v_xor_b32 v145, 32, v111
  v_add_u32 v149, 57344, v145
  v_xor_b32 v146, 64, v111
  v_add_u32 v150, 57344, v146
  v_xor_b32 v147, 96, v111
  v_add_u32 v151, 57344, v147
  v_and_b32 v110, 15, v1
  v_lshrrev_b32 v110, 2, v110
  v_lshl_add_u32 v110, v4, 3, v110
  v_lshlrev_b32 v110, 6, v110
  v_bfe_u32 v111, v1, 4, 1
  v_lshl_add_u32 v110, v111, 5, v110
  v_and_b32 v111, 3, v1
  v_lshl_add_u32 v110, v111, 3, v110
  v_add_u32 v152, 16384, v110
  v_add_u32 v153, 57344, v152
  v_add_u32 v154, 114688, v152
  v_lshlrev_b32 v5, 10, v4
  v_lshl_add_u32 v5, v3, 2, v5
  v_add_u32 v5, s70, v5
  s_lshl_b32 s66, s61, 1
  v_add_u32 v6, s66, v4
  v_sub_u32 v112, 7, v6
  v_and_b32 v113, 7, v3
  v_xor_b32 v112, v112, v113
  v_lshlrev_b32 v112, 4, v112
  v_lshl_add_u32 v112, v3, 8, v112
  v_add_u32 v112, 114688, v112
  v_lshrrev_b32 v114, 3, v1
  s_lshl_b32 s66, s72, 4
  v_add_u32 v114, s66, v114
  v_and_b32 v115, 7, v1
  v_lshrrev_b32 v116, 1, v114
  v_and_b32 v116, 7, v116
  v_xor_b32 v116, v116, v115
  v_lshlrev_b32 v117, 7, v114
  v_lshl_add_u32 v118, v116, 4, v117
  v_xor_b32 v116, 4, v116
  v_lshl_add_u32 v119, v116, 4, v117
  v_add_u32 v118, 114688, v118
  v_add_u32 v119, 115712, v119
  s_lshl_b32 s66, s63, 18
  s_lshl_b32 s67, s62, 7
  s_sub_u32 s66, s66, s67
  s_add_u32 s66, s66, 7344000
  v_lshlrev_b32 v120, 12, v114
  v_lshl_add_u32 v120, v115, 4, v120
  v_add_u32 v120, s66, v120
  v_add_u32 v121, 0x8000, v120
  s_waitcnt vmcnt(0) lgkmcnt(0)
  ds_read_b32 v16, v5 offset:640
  ds_read_b32 v17, v5 offset:768
  ds_read_b32 v18, v5 offset:896
  ds_read_b32 v19, v5 offset:1024
  ds_read_b32 v20, v5 offset:1152
  ds_read_b32 v21, v5 offset:1280
  ds_read_b32 v22, v5 offset:1408
  ds_read_b32 v23, v5 offset:1536
  ds_read_b32 v24, v5 offset:1664
  ds_read_b32 v25, v5 offset:1792
  ds_read_b32 v26, v5 offset:1920
  ds_read_b32 v28, v5 offset:3072
  ds_read_b32 v29, v5 offset:3200
  ds_read_b32 v30, v5 offset:3328
  ds_read_b32 v31, v5 offset:3456
  ds_read_b32 v32, v5 offset:3584
  ds_read_b32 v33, v5 offset:3712
  ds_read_b32 v34, v5 offset:3840
  ds_read_b32 v35, v5 offset:3968
  v_lshlrev_b32 v78, 16, v36
  v_lshlrev_b32 v79, 16, v38
  v_and_b32 v80, 0xffff0000, v36
  v_and_b32 v81, 0xffff0000, v38
  v_lshlrev_b32 v82, 16, v37
  v_lshlrev_b32 v83, 16, v39
  v_and_b32 v84, 0xffff0000, v37
  v_and_b32 v85, 0xffff0000, v39
  s_add_u32 s60, s60, 1
  s_waitcnt lgkmcnt(8)
  v_lshlrev_b32 v40, 16, v16
  v_and_b32 v41, 0xffff0000, v16
  v_lshlrev_b32 v42, 16, v17
  v_and_b32 v43, 0xffff0000, v17
  v_lshlrev_b32 v44, 16, v18
  v_and_b32 v45, 0xffff0000, v18
  v_lshlrev_b32 v46, 16, v19
  v_and_b32 v47, 0xffff0000, v19
  v_lshlrev_b32 v48, 16, v20
  v_and_b32 v49, 0xffff0000, v20
  v_lshlrev_b32 v50, 16, v21
  v_and_b32 v51, 0xffff0000, v21
  v_lshlrev_b32 v52, 16, v22
  v_and_b32 v53, 0xffff0000, v22
  v_lshlrev_b32 v54, 16, v23
  v_and_b32 v55, 0xffff0000, v23
  v_lshlrev_b32 v56, 16, v24
  v_and_b32 v57, 0xffff0000, v24
  v_lshlrev_b32 v58, 16, v25
  v_and_b32 v59, 0xffff0000, v25
  v_lshlrev_b32 v60, 16, v26
  v_and_b32 v61, 0xffff0000, v26
  v_pk_mul_f32 v[86:87], v[46:47], v[78:79]
  v_pk_mul_f32 v[88:89], v[48:49], v[78:79]
  v_pk_mul_f32 v[90:91], v[50:51], v[78:79]
  v_pk_mul_f32 v[92:93], v[52:53], v[78:79]
  v_pk_mul_f32 v[94:95], v[54:55], v[78:79]
  v_pk_mul_f32 v[96:97], v[56:57], v[78:79]
  v_pk_mul_f32 v[98:99], v[58:59], v[78:79]
  v_pk_mul_f32 v[100:101], v[60:61], v[78:79]
  v_pk_fma_f32 v[86:87], v[44:45], v[80:81], v[86:87]
  v_pk_fma_f32 v[88:89], v[46:47], v[80:81], v[88:89]
  v_pk_fma_f32 v[90:91], v[48:49], v[80:81], v[90:91]
  v_pk_fma_f32 v[92:93], v[50:51], v[80:81], v[92:93]
  v_pk_fma_f32 v[94:95], v[52:53], v[80:81], v[94:95]
  v_pk_fma_f32 v[96:97], v[54:55], v[80:81], v[96:97]
  v_pk_fma_f32 v[98:99], v[56:57], v[80:81], v[98:99]
  v_pk_fma_f32 v[100:101], v[58:59], v[80:81], v[100:101]
  v_pk_fma_f32 v[86:87], v[42:43], v[82:83], v[86:87]
  v_pk_fma_f32 v[88:89], v[44:45], v[82:83], v[88:89]
  v_pk_fma_f32 v[90:91], v[46:47], v[82:83], v[90:91]
  v_pk_fma_f32 v[92:93], v[48:49], v[82:83], v[92:93]
  v_pk_fma_f32 v[94:95], v[50:51], v[82:83], v[94:95]
  v_pk_fma_f32 v[96:97], v[52:53], v[82:83], v[96:97]
  v_pk_fma_f32 v[98:99], v[54:55], v[82:83], v[98:99]
  v_pk_fma_f32 v[100:101], v[56:57], v[82:83], v[100:101]
  v_pk_fma_f32 v[86:87], v[40:41], v[84:85], v[86:87]
  v_pk_fma_f32 v[88:89], v[42:43], v[84:85], v[88:89]
  v_pk_fma_f32 v[90:91], v[44:45], v[84:85], v[90:91]
  v_pk_fma_f32 v[92:93], v[46:47], v[84:85], v[92:93]
  v_pk_fma_f32 v[94:95], v[48:49], v[84:85], v[94:95]
  v_pk_fma_f32 v[96:97], v[50:51], v[84:85], v[96:97]
  v_pk_fma_f32 v[98:99], v[52:53], v[84:85], v[98:99]
  v_pk_fma_f32 v[100:101], v[54:55], v[84:85], v[100:101]
  s_waitcnt lgkmcnt(0)
  v_lshlrev_b32 v62, 16, v28
  v_and_b32 v63, 0xffff0000, v28
  v_lshlrev_b32 v64, 16, v29
  v_and_b32 v65, 0xffff0000, v29
  v_lshlrev_b32 v66, 16, v30
  v_and_b32 v67, 0xffff0000, v30
  v_lshlrev_b32 v68, 16, v31
  v_and_b32 v69, 0xffff0000, v31
  v_lshlrev_b32 v70, 16, v32
  v_and_b32 v71, 0xffff0000, v32
  v_lshlrev_b32 v72, 16, v33
  v_and_b32 v73, 0xffff0000, v33
  v_lshlrev_b32 v74, 16, v34
  v_and_b32 v75, 0xffff0000, v34
  v_lshlrev_b32 v76, 16, v35
  v_and_b32 v77, 0xffff0000, v35
  v_pk_mul_f32 v[86:87], v[86:87], v[62:63]
  v_pk_mul_f32 v[88:89], v[88:89], v[64:65]
  v_pk_mul_f32 v[90:91], v[90:91], v[66:67]
  v_pk_mul_f32 v[92:93], v[92:93], v[68:69]
  v_pk_mul_f32 v[94:95], v[94:95], v[70:71]
  v_pk_mul_f32 v[96:97], v[96:97], v[72:73]
  v_pk_mul_f32 v[98:99], v[98:99], v[74:75]
  v_pk_mul_f32 v[100:101], v[100:101], v[76:77]
  v_cvt_pk_bf16_f32 v104, v100, v98
  v_cvt_pk_bf16_f32 v108, v101, v99
  v_cvt_pk_bf16_f32 v105, v96, v94
  v_cvt_pk_bf16_f32 v109, v97, v95
  v_cvt_pk_bf16_f32 v106, v92, v90
  v_cvt_pk_bf16_f32 v110, v93, v91
  v_cvt_pk_bf16_f32 v107, v88, v86
  v_cvt_pk_bf16_f32 v111, v89, v87
  ds_write_b128 v112, v[104:107]
  ds_write_b128 v112, v[108:111] offset:128
  s_sub_u32 s66, s60, 1
  v_mov_b32 v156, s66
  v_mov_b32 v16, 163824
  ds_write_b32 v16, v156
  s_waitcnt lgkmcnt(0)
  s_barrier
  ds_read_b128 v[24:27], v118
  ds_read_b128 v[28:31], v119
  ds_read_b128 v[160:163], v144 offset:0
  ds_read_b64_tr_b16 v[164:165], v152 offset:0
  ds_read_b64_tr_b16 v[166:167], v152 offset:256
  ds_read_b64_tr_b16 v[168:169], v152 offset:4096
  ds_read_b64_tr_b16 v[170:171], v152 offset:4352
  ds_read_b64_tr_b16 v[172:173], v152 offset:8192
  ds_read_b64_tr_b16 v[174:175], v152 offset:8448
  s_waitcnt lgkmcnt(7)
  global_store_dwordx4 v120, v[24:27], s[38:39] sc1
  global_store_dwordx4 v121, v[28:31], s[38:39] sc1
  ds_read_b128 v[176:179], v145 offset:0
  ds_read_b64_tr_b16 v[180:181], v152 offset:1024
  ds_read_b64_tr_b16 v[182:183], v152 offset:1280
  ds_read_b64_tr_b16 v[184:185], v152 offset:5120
  ds_read_b64_tr_b16 v[186:187], v152 offset:5376
  ds_read_b64_tr_b16 v[188:189], v152 offset:9216
  ds_read_b64_tr_b16 v[190:191], v152 offset:9472
  s_waitcnt lgkmcnt(7)
  v_mfma_f32_32x32x16_bf16 v[64:79], v[164:167], v[160:163], 0
  ds_read_b128 v[128:131], v146 offset:0
  ds_read_b64_tr_b16 v[132:133], v152 offset:2048
  ds_read_b64_tr_b16 v[134:135], v152 offset:2304
  v_mfma_f32_32x32x16_bf16 v[80:95], v[168:171], v[160:163], 0
  ds_read_b64_tr_b16 v[136:137], v152 offset:6144
  ds_read_b64_tr_b16 v[138:139], v152 offset:6400
  v_mfma_f32_32x32x16_bf16 v[96:111], v[160:163], v[172:175], 0
  ds_read_b64_tr_b16 v[140:141], v152 offset:10240
  ds_read_b64_tr_b16 v[142:143], v152 offset:10496
  s_waitcnt lgkmcnt(7)
  v_mfma_f32_32x32x16_bf16 v[64:79], v[180:183], v[176:179], v[64:79]
  ds_read_b128 v[160:163], v147 offset:0
  ds_read_b64_tr_b16 v[164:165], v152 offset:3072
  ds_read_b64_tr_b16 v[166:167], v152 offset:3328
  v_mfma_f32_32x32x16_bf16 v[80:95], v[184:187], v[176:179], v[80:95]
  ds_read_b64_tr_b16 v[168:169], v152 offset:7168
  ds_read_b64_tr_b16 v[170:171], v152 offset:7424
  v_mfma_f32_32x32x16_bf16 v[96:111], v[176:179], v[188:191], v[96:111]
  ds_read_b64_tr_b16 v[172:173], v152 offset:11264
  ds_read_b64_tr_b16 v[174:175], v152 offset:11520
  s_waitcnt lgkmcnt(0)
  v_lshlrev_b32 v32, 4, v1
  s_lshl_b32 s66, s65, 7
  s_lshl_b32 s67, s64, 2
  s_add_u32 s66, s66, s67
  s_add_u32 s66, s66, s72
  s_lshl_b32 s66, s66, 10
  s_add_u32 s67, s66, 1048576
  v_add_u32 v37, s67, v32
  v_add_u32 v38, 0x10000, v37
  v_and_b32 v34, 15, v1
  v_lshlrev_b32 v34, 4, v34
  v_lshl_add_u32 v34, v4, 8, v34
  v_bfe_u32 v35, v1, 4, 1
  s_add_u32 s67, s66, 3145728
  v_lshlrev_b32 v39, 16, v35
  v_add3_u32 v39, v39, v34, s67
  s_lshl_b32 s66, s72, 10
  v_add_u32 v33, s66, v32
  s_mul_i32 s66, s72, 1040
  v_mov_b32 v36, 12480
  v_mul_u32_u24 v36, v36, v35
  v_add3_u32 v36, v36, v34, s66
  s_barrier
  v_mfma_f32_32x32x16_bf16 v[64:79], v[132:135], v[128:131], v[64:79]
  ds_read_b128 v[176:179], v144 offset:28672
  ds_read_b64_tr_b16 v[180:181], v152 offset:28672
  ds_read_b64_tr_b16 v[182:183], v152 offset:28928
  v_mfma_f32_32x32x16_bf16 v[80:95], v[136:139], v[128:131], v[80:95]
  ds_read_b64_tr_b16 v[184:185], v152 offset:32768
  ds_read_b64_tr_b16 v[186:187], v152 offset:33024
  v_mfma_f32_32x32x16_bf16 v[96:111], v[128:131], v[140:143], v[96:111]
  ds_read_b64_tr_b16 v[188:189], v152 offset:36864
  ds_read_b64_tr_b16 v[190:191], v152 offset:37120
  s_waitcnt lgkmcnt(7)
  v_mfma_f32_32x32x16_bf16 v[64:79], v[164:167], v[160:163], v[64:79]
  ds_read_b128 v[128:131], v145 offset:28672
  ds_read_b64_tr_b16 v[132:133], v152 offset:29696
  ds_read_b64_tr_b16 v[134:135], v152 offset:29952
  v_mfma_f32_32x32x16_bf16 v[80:95], v[168:171], v[160:163], v[80:95]
  ds_read_b64_tr_b16 v[136:137], v152 offset:33792
  ds_read_b64_tr_b16 v[138:139], v152 offset:34048
  v_mfma_f32_32x32x16_bf16 v[96:111], v[160:163], v[172:175], v[96:111]
  ds_read_b64_tr_b16 v[140:141], v152 offset:37888
  ds_read_b64_tr_b16 v[142:143], v152 offset:38144
  s_waitcnt lgkmcnt(7)
  v_mfma_f32_32x32x16_bf16 v[64:79], v[180:183], v[176:179], v[64:79]
  ds_read_b128 v[160:163], v146 offset:28672
  ds_read_b64_tr_b16 v[164:165], v152 offset:30720
  ds_read_b64_tr_b16 v[166:167], v152 offset:30976
  v_mfma_f32_32x32x16_bf16 v[80:95], v[184:187], v[176:179], v[80:95]
  ds_read_b64_tr_b16 v[168:169], v152 offset:34816
  ds_read_b64_tr_b16 v[170:171], v152 offset:35072
  v_mfma_f32_32x32x16_bf16 v[96:111], v[176:179], v[188:191], v[96:111]
  ds_read_b64_tr_b16 v[172:173], v152 offset:38912
  ds_read_b64_tr_b16 v[174:175], v152 offset:39168
  s_waitcnt lgkmcnt(7)
  v_mfma_f32_32x32x16_bf16 v[64:79], v[132:135], v[128:131], v[64:79]
  ds_read_b128 v[176:179], v147 offset:28672
  ds_read_b64_tr_b16 v[180:181], v152 offset:31744
  ds_read_b64_tr_b16 v[182:183], v152 offset:32000
  v_mfma_f32_32x32x16_bf16 v[80:95], v[136:139], v[128:131], v[80:95]
  ds_read_b64_tr_b16 v[184:185], v152 offset:35840
  ds_read_b64_tr_b16 v[186:187], v152 offset:36096
  v_mfma_f32_32x32x16_bf16 v[96:111], v[128:131], v[140:143], v[96:111]
  ds_read_b64_tr_b16 v[188:189], v152 offset:39936
  ds_read_b64_tr_b16 v[190:191], v152 offset:40192
  s_waitcnt lgkmcnt(0)
  s_mov_b32 s52, s38
  s_and_b32 s53, s39, 0xffff
  s_mov_b32 s54, 11534336
  s_mov_b32 s55, 0x00020000
  s_sub_u32 s68, s64, 1
  s_sub_u32 s69, s64, 2
  s_max_i32 s69, s69, 0
  s_max_i32 s68, s68, 0
  v_and_b32 v158, 1, v1
  v_cmp_eq_u32 vcc, 1, v158
  v_mov_b32 v158, s68
  v_mov_b32 v157, s69
  v_cndmask_b32 v158, v158, v157, vcc
  s_and_b32 s66, s65, 7
  s_lshl_b32 s66, s66, 5
  s_lshr_b32 s67, s65, 3
  s_add_u32 s66, s66, s67
  v_and_b32 v157, 3, v158
  v_lshlrev_b32 v157, 3, v157
  v_lshrrev_b32 v158, 2, v158
  v_lshrrev_b32 v159, 1, v158
  v_xor_b32 v158, v158, v159
  v_lshl_add_u32 v157, v158, 1, v157
  v_add_u32 v157, s66, v157
  v_lshlrev_b32 v157, 10, v157
  s_lshl_b32 s66, s72, 7
  s_add_u32 s66, s66, 262144
  v_add_u32 v157, s66, v157
  s_barrier
  v_mfma_f32_32x32x16_bf16 v[64:79], v[164:167], v[160:163], v[64:79]
  ds_read_b128 v[128:131], v148 offset:0
  ds_read_b64_tr_b16 v[132:133], v153 offset:0
  ds_read_b64_tr_b16 v[134:135], v153 offset:256
  v_mfma_f32_32x32x16_bf16 v[80:95], v[168:171], v[160:163], v[80:95]
  ds_read_b64_tr_b16 v[136:137], v153 offset:4096
  ds_read_b64_tr_b16 v[138:139], v153 offset:4352
  v_mfma_f32_32x32x16_bf16 v[96:111], v[160:163], v[172:175], v[96:111]
  ds_read_b64_tr_b16 v[140:141], v153 offset:8192
  ds_read_b64_tr_b16 v[142:143], v153 offset:8448
  s_waitcnt lgkmcnt(7)
  v_mfma_f32_32x32x16_bf16 v[64:79], v[180:183], v[176:179], v[64:79]
  ds_read_b128 v[160:163], v149 offset:0
  ds_read_b64_tr_b16 v[164:165], v153 offset:1024
  ds_read_b64_tr_b16 v[166:167], v153 offset:1280
  v_mfma_f32_32x32x16_bf16 v[80:95], v[184:187], v[176:179], v[80:95]
  ds_read_b64_tr_b16 v[168:169], v153 offset:5120
  ds_read_b64_tr_b16 v[170:171], v153 offset:5376
  v_mfma_f32_32x32x16_bf16 v[96:111], v[176:179], v[188:191], v[96:111]
  ds_read_b64_tr_b16 v[172:173], v153 offset:9216
  ds_read_b64_tr_b16 v[174:175], v153 offset:9472
  s_waitcnt lgkmcnt(7)
  v_mfma_f32_32x32x16_bf16 v[64:79], v[132:135], v[128:131], v[64:79]
  ds_read_b128 v[176:179], v150 offset:0
  ds_read_b64_tr_b16 v[180:181], v153 offset:2048
  ds_read_b64_tr_b16 v[182:183], v153 offset:2304
  v_mfma_f32_32x32x16_bf16 v[80:95], v[136:139], v[128:131], v[80:95]
  ds_read_b64_tr_b16 v[184:185], v153 offset:6144
  ds_read_b64_tr_b16 v[186:187], v153 offset:6400
  v_mfma_f32_32x32x16_bf16 v[96:111], v[128:131], v[140:143], v[96:111]
  ds_read_b64_tr_b16 v[188:189], v153 offset:10240
  ds_read_b64_tr_b16 v[190:191], v153 offset:10496
  s_waitcnt lgkmcnt(7)
  v_mfma_f32_32x32x16_bf16 v[64:79], v[164:167], v[160:163], v[64:79]
  ds_read_b128 v[128:131], v151 offset:0
  ds_read_b64_tr_b16 v[132:133], v153 offset:3072
  ds_read_b64_tr_b16 v[134:135], v153 offset:3328
  v_mfma_f32_32x32x16_bf16 v[80:95], v[168:171], v[160:163], v[80:95]
  ds_read_b64_tr_b16 v[136:137], v153 offset:7168
  ds_read_b64_tr_b16 v[138:139], v153 offset:7424
  v_mfma_f32_32x32x16_bf16 v[96:111], v[160:163], v[172:175], v[96:111]
  ds_read_b64_tr_b16 v[140:141], v153 offset:11264
  ds_read_b64_tr_b16 v[142:143], v153 offset:11520
  s_waitcnt lgkmcnt(0)
  s_waitcnt vmcnt(0)
  s_lshl_b32 s66, s2, 7
  s_lshl_b32 s67, s61, 2
  s_add_u32 s66, s66, s67
  s_add_u32 s66, s66, 0
  v_mov_b32 v16, s66
  v_mov_b32 v17, s60
  s_mov_b64 s[76:77], exec
  s_mov_b64 exec, 1
  global_store_dword v16, v17, s[38:39] sc1
  s_mov_b64 exec, s[76:77]
  s_barrier
  v_mfma_f32_32x32x16_bf16 v[64:79], v[180:183], v[176:179], v[64:79]
  ds_read_b128 v[160:163], v148 offset:28672
  ds_read_b64_tr_b16 v[164:165], v153 offset:28672
  ds_read_b64_tr_b16 v[166:167], v153 offset:28928
  v_mfma_f32_32x32x16_bf16 v[80:95], v[184:187], v[176:179], v[80:95]
  ds_read_b64_tr_b16 v[168:169], v153 offset:32768
  ds_read_b64_tr_b16 v[170:171], v153 offset:33024
  v_mfma_f32_32x32x16_bf16 v[96:111], v[176:179], v[188:191], v[96:111]
  ds_read_b64_tr_b16 v[172:173], v153 offset:36864
  ds_read_b64_tr_b16 v[174:175], v153 offset:37120
  s_waitcnt lgkmcnt(7)
  v_mfma_f32_32x32x16_bf16 v[64:79], v[132:135], v[128:131], v[64:79]
  ds_read_b128 v[176:179], v149 offset:28672
  ds_read_b64_tr_b16 v[180:181], v153 offset:29696
  ds_read_b64_tr_b16 v[182:183], v153 offset:29952
  v_mfma_f32_32x32x16_bf16 v[80:95], v[136:139], v[128:131], v[80:95]
  ds_read_b64_tr_b16 v[184:185], v153 offset:33792
  ds_read_b64_tr_b16 v[186:187], v153 offset:34048
  v_mfma_f32_32x32x16_bf16 v[96:111], v[128:131], v[140:143], v[96:111]
  ds_read_b64_tr_b16 v[188:189], v153 offset:37888
  ds_read_b64_tr_b16 v[190:191], v153 offset:38144
  s_waitcnt lgkmcnt(7)
  v_mfma_f32_32x32x16_bf16 v[64:79], v[164:167], v[160:163], v[64:79]
  ds_read_b128 v[128:131], v150 offset:28672
  ds_read_b64_tr_b16 v[132:133], v153 offset:30720
  ds_read_b64_tr_b16 v[134:135], v153 offset:30976
  v_mfma_f32_32x32x16_bf16 v[80:95], v[168:171], v[160:163], v[80:95]
  ds_read_b64_tr_b16 v[136:137], v153 offset:34816
  ds_read_b64_tr_b16 v[138:139], v153 offset:35072
  v_mfma_f32_32x32x16_bf16 v[96:111], v[160:163], v[172:175], v[96:111]
  ds_read_b64_tr_b16 v[140:141], v153 offset:38912
  ds_read_b64_tr_b16 v[142:143], v153 offset:39168
  s_waitcnt lgkmcnt(7)
  v_mfma_f32_32x32x16_bf16 v[64:79], v[180:183], v[176:179], v[64:79]
  ds_read_b128 v[160:163], v151 offset:28672
  ds_read_b64_tr_b16 v[164:165], v153 offset:31744
  ds_read_b64_tr_b16 v[166:167], v153 offset:32000
  v_mfma_f32_32x32x16_bf16 v[80:95], v[184:187], v[176:179], v[80:95]
  ds_read_b64_tr_b16 v[168:169], v153 offset:35840
  ds_read_b64_tr_b16 v[170:171], v153 offset:36096
  v_mfma_f32_32x32x16_bf16 v[96:111], v[176:179], v[188:191], v[96:111]
  ds_read_b64_tr_b16 v[172:173], v153 offset:39936
  ds_read_b64_tr_b16 v[174:175], v153 offset:40192
  s_waitcnt lgkmcnt(0)
  s_barrier
  v_mfma_f32_32x32x16_bf16 v[64:79], v[132:135], v[128:131], v[64:79]
  ds_read_b128 v[176:179], v144 offset:0
  ds_read_b64_tr_b16 v[180:181], v152 offset:0
  ds_read_b64_tr_b16 v[182:183], v152 offset:256
  v_mfma_f32_32x32x16_bf16 v[80:95], v[136:139], v[128:131], v[80:95]
  ds_read_b64_tr_b16 v[184:185], v152 offset:4096
  ds_read_b64_tr_b16 v[186:187], v152 offset:4352
  v_mfma_f32_32x32x16_bf16 v[96:111], v[128:131], v[140:143], v[96:111]
  ds_read_b64_tr_b16 v[188:189], v152 offset:8192
  ds_read_b64_tr_b16 v[190:191], v152 offset:8448
  s_waitcnt lgkmcnt(7)
  v_mfma_f32_32x32x16_bf16 v[64:79], v[164:167], v[160:163], v[64:79]
  ds_read_b128 v[128:131], v145 offset:0
  ds_read_b64_tr_b16 v[132:133], v152 offset:1024
  ds_read_b64_tr_b16 v[134:135], v152 offset:1280
  v_mfma_f32_32x32x16_bf16 v[80:95], v[168:171], v[160:163], v[80:95]
  ds_read_b64_tr_b16 v[136:137], v152 offset:5120
  ds_read_b64_tr_b16 v[138:139], v152 offset:5376
  v_mfma_f32_32x32x16_bf16 v[96:111], v[160:163], v[172:175], v[96:111]
  ds_read_b64_tr_b16 v[140:141], v152 offset:9216
  ds_read_b64_tr_b16 v[142:143], v152 offset:9472
  s_waitcnt lgkmcnt(7)
  v_mfma_f32_32x32x16_bf16 v[64:79], v[180:183], v[176:179], v[64:79]
  ds_read_b128 v[160:163], v146 offset:0
  ds_read_b64_tr_b16 v[164:165], v152 offset:2048
  ds_read_b64_tr_b16 v[166:167], v152 offset:2304
  v_mfma_f32_32x32x16_bf16 v[80:95], v[184:187], v[176:179], v[80:95]
  ds_read_b64_tr_b16 v[168:169], v152 offset:6144
  ds_read_b64_tr_b16 v[170:171], v152 offset:6400
  v_mfma_f32_32x32x16_bf16 v[96:111], v[176:179], v[188:191], v[96:111]
  ds_read_b64_tr_b16 v[172:173], v152 offset:10240
  ds_read_b64_tr_b16 v[174:175], v152 offset:10496
  s_waitcnt lgkmcnt(7)
  v_mfma_f32_32x32x16_bf16 v[64:79], v[132:135], v[128:131], v[64:79]
  ds_read_b128 v[176:179], v147 offset:0
  ds_read_b64_tr_b16 v[180:181], v152 offset:3072
  ds_read_b64_tr_b16 v[182:183], v152 offset:3328
  v_mfma_f32_32x32x16_bf16 v[80:95], v[136:139], v[128:131], v[80:95]
  ds_read_b64_tr_b16 v[184:185], v152 offset:7168
  ds_read_b64_tr_b16 v[186:187], v152 offset:7424
  v_mfma_f32_32x32x16_bf16 v[96:111], v[128:131], v[140:143], v[96:111]
  ds_read_b64_tr_b16 v[188:189], v152 offset:11264
  ds_read_b64_tr_b16 v[190:191], v152 offset:11520
  s_waitcnt lgkmcnt(0)
  s_barrier
  v_mfma_f32_32x32x16_bf16 v[64:79], v[164:167], v[160:163], v[64:79]
  ds_read_b128 v[128:131], v144 offset:28672
  ds_read_b64_tr_b16 v[132:133], v152 offset:28672
  ds_read_b64_tr_b16 v[134:135], v152 offset:28928
  v_mfma_f32_32x32x16_bf16 v[80:95], v[168:171], v[160:163], v[80:95]
  ds_read_b64_tr_b16 v[136:137], v152 offset:32768
  ds_read_b64_tr_b16 v[138:139], v152 offset:33024
  v_mfma_f32_32x32x16_bf16 v[96:111], v[160:163], v[172:175], v[96:111]
  ds_read_b64_tr_b16 v[140:141], v152 offset:36864
  ds_read_b64_tr_b16 v[142:143], v152 offset:37120
  s_waitcnt lgkmcnt(7)
  v_mfma_f32_32x32x16_bf16 v[64:79], v[180:183], v[176:179], v[64:79]
  ds_read_b128 v[160:163], v145 offset:28672
  ds_read_b64_tr_b16 v[164:165], v152 offset:29696
  ds_read_b64_tr_b16 v[166:167], v152 offset:29952
  v_mfma_f32_32x32x16_bf16 v[80:95], v[184:187], v[176:179], v[80:95]
  ds_read_b64_tr_b16 v[168:169], v152 offset:33792
  ds_read_b64_tr_b16 v[170:171], v152 offset:34048
  v_mfma_f32_32x32x16_bf16 v[96:111], v[176:179], v[188:191], v[96:111]
  ds_read_b64_tr_b16 v[172:173], v152 offset:37888
  ds_read_b64_tr_b16 v[174:175], v152 offset:38144
  s_waitcnt lgkmcnt(7)
  v_mfma_f32_32x32x16_bf16 v[64:79], v[132:135], v[128:131], v[64:79]
  ds_read_b128 v[176:179], v146 offset:28672
  ds_read_b64_tr_b16 v[180:181], v152 offset:30720
  ds_read_b64_tr_b16 v[182:183], v152 offset:30976
  v_mfma_f32_32x32x16_bf16 v[80:95], v[136:139], v[128:131], v[80:95]
  ds_read_b64_tr_b16 v[184:185], v152 offset:34816
  ds_read_b64_tr_b16 v[186:187], v152 offset:35072
  v_mfma_f32_32x32x16_bf16 v[96:111], v[128:131], v[140:143], v[96:111]
  ds_read_b64_tr_b16 v[188:189], v152 offset:38912
  ds_read_b64_tr_b16 v[190:191], v152 offset:39168
  s_waitcnt lgkmcnt(7)
  v_mfma_f32_32x32x16_bf16 v[64:79], v[164:167], v[160:163], v[64:79]
  ds_read_b128 v[128:131], v147 offset:28672
  ds_read_b64_tr_b16 v[132:133], v152 offset:31744
  ds_read_b64_tr_b16 v[134:135], v152 offset:32000
  v_mfma_f32_32x32x16_bf16 v[80:95], v[168:171], v[160:163], v[80:95]
  ds_read_b64_tr_b16 v[136:137], v152 offset:35840
  ds_read_b64_tr_b16 v[138:139], v152 offset:36096
  v_mfma_f32_32x32x16_bf16 v[96:111], v[160:163], v[172:175], v[96:111]
  ds_read_b64_tr_b16 v[140:141], v152 offset:39936
  ds_read_b64_tr_b16 v[142:143], v152 offset:40192
  s_waitcnt lgkmcnt(0)
  s_barrier
  v_mfma_f32_32x32x16_bf16 v[64:79], v[180:183], v[176:179], v[64:79]
  ds_read_b128 v[160:163], v148 offset:0
  ds_read_b64_tr_b16 v[164:165], v153 offset:0
  ds_read_b64_tr_b16 v[166:167], v153 offset:256
  v_mfma_f32_32x32x16_bf16 v[80:95], v[184:187], v[176:179], v[80:95]
  ds_read_b64_tr_b16 v[168:169], v153 offset:4096
  ds_read_b64_tr_b16 v[170:171], v153 offset:4352
  v_mfma_f32_32x32x16_bf16 v[96:111], v[176:179], v[188:191], v[96:111]
  ds_read_b64_tr_b16 v[172:173], v153 offset:8192
  ds_read_b64_tr_b16 v[174:175], v153 offset:8448
  s_waitcnt lgkmcnt(7)
  v_mfma_f32_32x32x16_bf16 v[64:79], v[132:135], v[128:131], v[64:79]
  ds_read_b128 v[176:179], v149 offset:0
  ds_read_b64_tr_b16 v[180:181], v153 offset:1024
  ds_read_b64_tr_b16 v[182:183], v153 offset:1280
  v_mfma_f32_32x32x16_bf16 v[80:95], v[136:139], v[128:131], v[80:95]
  ds_read_b64_tr_b16 v[184:185], v153 offset:5120
  ds_read_b64_tr_b16 v[186:187], v153 offset:5376
  v_mfma_f32_32x32x16_bf16 v[96:111], v[128:131], v[140:143], v[96:111]
  ds_read_b64_tr_b16 v[188:189], v153 offset:9216
  ds_read_b64_tr_b16 v[190:191], v153 offset:9472
  s_waitcnt lgkmcnt(7)
  v_mfma_f32_32x32x16_bf16 v[64:79], v[164:167], v[160:163], v[64:79]
  ds_read_b128 v[128:131], v150 offset:0
  ds_read_b64_tr_b16 v[132:133], v153 offset:2048
  ds_read_b64_tr_b16 v[134:135], v153 offset:2304
  v_mfma_f32_32x32x16_bf16 v[80:95], v[168:171], v[160:163], v[80:95]
  ds_read_b64_tr_b16 v[136:137], v153 offset:6144
  ds_read_b64_tr_b16 v[138:139], v153 offset:6400
  v_mfma_f32_32x32x16_bf16 v[96:111], v[160:163], v[172:175], v[96:111]
  ds_read_b64_tr_b16 v[140:141], v153 offset:10240
  ds_read_b64_tr_b16 v[142:143], v153 offset:10496
  s_waitcnt lgkmcnt(7)
  v_mfma_f32_32x32x16_bf16 v[64:79], v[180:183], v[176:179], v[64:79]
  ds_read_b128 v[160:163], v151 offset:0
  ds_read_b64_tr_b16 v[164:165], v153 offset:3072
  ds_read_b64_tr_b16 v[166:167], v153 offset:3328
  v_mfma_f32_32x32x16_bf16 v[80:95], v[184:187], v[176:179], v[80:95]
  ds_read_b64_tr_b16 v[168:169], v153 offset:7168
  ds_read_b64_tr_b16 v[170:171], v153 offset:7424
  v_mfma_f32_32x32x16_bf16 v[96:111], v[176:179], v[188:191], v[96:111]
  ds_read_b64_tr_b16 v[172:173], v153 offset:11264
  ds_read_b64_tr_b16 v[174:175], v153 offset:11520
  s_waitcnt lgkmcnt(0)
  s_barrier
  v_mfma_f32_32x32x16_bf16 v[64:79], v[132:135], v[128:131], v[64:79]
  ds_read_b128 v[176:179], v148 offset:28672
  ds_read_b64_tr_b16 v[180:181], v153 offset:28672
  ds_read_b64_tr_b16 v[182:183], v153 offset:28928
  v_mfma_f32_32x32x16_bf16 v[80:95], v[136:139], v[128:131], v[80:95]
  ds_read_b64_tr_b16 v[184:185], v153 offset:32768
  ds_read_b64_tr_b16 v[186:187], v153 offset:33024
  v_mfma_f32_32x32x16_bf16 v[96:111], v[128:131], v[140:143], v[96:111]
  ds_read_b64_tr_b16 v[188:189], v153 offset:36864
  ds_read_b64_tr_b16 v[190:191], v153 offset:37120
  s_waitcnt lgkmcnt(7)
  v_mfma_f32_32x32x16_bf16 v[64:79], v[164:167], v[160:163], v[64:79]
  ds_read_b128 v[128:131], v149 offset:28672
  ds_read_b64_tr_b16 v[132:133], v153 offset:29696
  ds_read_b64_tr_b16 v[134:135], v153 offset:29952
  v_mfma_f32_32x32x16_bf16 v[80:95], v[168:171], v[160:163], v[80:95]
  ds_read_b64_tr_b16 v[136:137], v153 offset:33792
  ds_read_b64_tr_b16 v[138:139], v153 offset:34048
  v_mfma_f32_32x32x16_bf16 v[96:111], v[160:163], v[172:175], v[96:111]
  ds_read_b64_tr_b16 v[140:141], v153 offset:37888
  ds_read_b64_tr_b16 v[142:143], v153 offset:38144
  s_waitcnt lgkmcnt(7)
  v_mfma_f32_32x32x16_bf16 v[64:79], v[180:183], v[176:179], v[64:79]
  ds_read_b128 v[160:163], v150 offset:28672
  ds_read_b64_tr_b16 v[164:165], v153 offset:30720
  ds_read_b64_tr_b16 v[166:167], v153 offset:30976
  v_mfma_f32_32x32x16_bf16 v[80:95], v[184:187], v[176:179], v[80:95]
  ds_read_b64_tr_b16 v[168:169], v153 offset:34816
  ds_read_b64_tr_b16 v[170:171], v153 offset:35072
  v_mfma_f32_32x32x16_bf16 v[96:111], v[176:179], v[188:191], v[96:111]
  ds_read_b64_tr_b16 v[172:173], v153 offset:38912
  ds_read_b64_tr_b16 v[174:175], v153 offset:39168
  s_waitcnt lgkmcnt(7)
  v_mfma_f32_32x32x16_bf16 v[64:79], v[132:135], v[128:131], v[64:79]
  ds_read_b128 v[176:179], v151 offset:28672
  ds_read_b64_tr_b16 v[180:181], v153 offset:31744
  ds_read_b64_tr_b16 v[182:183], v153 offset:32000
  v_mfma_f32_32x32x16_bf16 v[80:95], v[136:139], v[128:131], v[80:95]
  ds_read_b64_tr_b16 v[184:185], v153 offset:35840
  ds_read_b64_tr_b16 v[186:187], v153 offset:36096
  v_mfma_f32_32x32x16_bf16 v[96:111], v[128:131], v[140:143], v[96:111]
  ds_read_b64_tr_b16 v[188:189], v153 offset:39936
  ds_read_b64_tr_b16 v[190:191], v153 offset:40192
  s_waitcnt lgkmcnt(7)
  v_mfma_f32_32x32x16_bf16 v[64:79], v[164:167], v[160:163], v[64:79]
  v_mfma_f32_32x32x16_bf16 v[80:95], v[168:171], v[160:163], v[80:95]
  v_mfma_f32_32x32x16_bf16 v[96:111], v[160:163], v[172:175], v[96:111]
  s_waitcnt lgkmcnt(0)
  v_mfma_f32_32x32x16_bf16 v[64:79], v[180:183], v[176:179], v[64:79]
  v_mfma_f32_32x32x16_bf16 v[80:95], v[184:187], v[176:179], v[80:95]
  v_mfma_f32_32x32x16_bf16 v[96:111], v[176:179], v[188:191], v[96:111]
  s_nop 10
  v_cvt_pk_bf16_f32 v120, v80, v81
  v_cvt_pk_bf16_f32 v121, v82, v83
  v_cvt_pk_bf16_f32 v122, v84, v85
  v_cvt_pk_bf16_f32 v123, v86, v87
  v_cvt_pk_bf16_f32 v124, v88, v89
  v_cvt_pk_bf16_f32 v125, v90, v91
  v_cvt_pk_bf16_f32 v126, v92, v93
  v_cvt_pk_bf16_f32 v127, v94, v95
  global_store_dwordx4 v37, v[120:123], s[38:39] sc1
  global_store_dwordx4 v38, v[124:127], s[38:39] sc1
  v_cvt_pk_bf16_f32 v128, v96, v97
  v_cvt_pk_bf16_f32 v129, v98, v99
  v_cvt_pk_bf16_f32 v130, v100, v101
  v_cvt_pk_bf16_f32 v131, v102, v103
  v_cvt_pk_bf16_f32 v132, v104, v105
  v_cvt_pk_bf16_f32 v133, v106, v107
  v_cvt_pk_bf16_f32 v134, v108, v109
  v_cvt_pk_bf16_f32 v135, v110, v111
  global_store_dwordx4 v39, v[128:131], s[38:39] sc1
  global_store_dwordx4 v39, v[132:135], s[38:39] offset:512 sc1
  s_mov_b32 s66, 1052289595
  v_mul_f32 v64, s66, v64
  v_mul_f32 v65, s66, v65
  v_mul_f32 v66, s66, v66
  v_mul_f32 v67, s66, v67
  v_mul_f32 v68, s66, v68
  v_mul_f32 v69, s66, v69
  v_mul_f32 v70, s66, v70
  v_mul_f32 v71, s66, v71
  v_mul_f32 v72, s66, v72
  v_mul_f32 v73, s66, v73
  v_mul_f32 v74, s66, v74
  v_mul_f32 v75, s66, v75
  v_mul_f32 v76, s66, v76
  v_mul_f32 v77, s66, v77
  v_mul_f32 v78, s66, v78
  v_mul_f32 v79, s66, v79
  v_cvt_pk_bf16_f32 v112, v64, v65
  v_cvt_pk_bf16_f32 v113, v66, v67
  v_cvt_pk_bf16_f32 v114, v68, v69
  v_cvt_pk_bf16_f32 v115, v70, v71
  v_cvt_pk_bf16_f32 v116, v72, v73
  v_cvt_pk_bf16_f32 v117, v74, v75
  v_cvt_pk_bf16_f32 v118, v76, v77
  v_cvt_pk_bf16_f32 v119, v78, v79
  ds_write_b128 v33, v[120:123] offset:8192
  ds_write_b128 v33, v[124:127] offset:20480
  ds_write_b128 v36, v[128:131] offset:32896
  ds_write_b128 v36, v[132:135] offset:33408
  ds_write_b128 v33, v[112:115] offset:49536
  ds_write_b128 v33, v[116:119] offset:53632
  s_cmp_lg_u32 s72, 0
  s_cbranch_scc1 L_c_nopad
  v_mov_b32 v24, 1065369472
  v_mov_b32 v25, v24
  v_mov_b32 v26, v24
  v_mov_b32 v27, v24
  v_mul_u32_u24 v28, 1040, v1
  v_cmp_gt_u32 vcc, 24, v1
  s_nop 3
  s_and_saveexec_b64 s[76:77], vcc
  ds_write_b128 v28, v[24:27] offset:25600
  s_mov_b64 exec, s[76:77]
L_c_nopad:
  s_waitcnt vmcnt(0)
  s_lshl_b32 s66, s2, 3
  s_add_u32 s66, s66, s61
  s_lshl_b32 s66, s66, 7
  s_add_u32 s66, s66, 262144
  v_mov_b32 v16, s66
  v_mov_b32 v17, s60
  s_mov_b64 s[76:77], exec
  s_mov_b64 exec, 1
  global_store_dword v16, v17, s[38:39] sc1
  s_mov_b64 exec, s[76:77]
  s_mov_b32 s70, s68
  s_mov_b32 s71, s69
  v_and_b32 v248, 31, v1
  v_lshrrev_b32 v249, 5, v1
  v_lshlrev_b32 v249, 2, v249
  v_sub_u32 v248, v248, v249
  v_mov_b32 v249, 4048155338
  v_mov_b32 v250, 0xffff
  v_subrev_u32 v208, 0, v248
  v_subrev_u32 v209, 1, v248
  v_subrev_u32 v210, 2, v248
  v_subrev_u32 v211, 3, v248
  v_subrev_u32 v212, 8, v248
  v_subrev_u32 v213, 9, v248
  v_subrev_u32 v214, 10, v248
  v_subrev_u32 v215, 11, v248
  v_subrev_u32 v216, 16, v248
  v_subrev_u32 v217, 17, v248
  v_subrev_u32 v218, 18, v248
  v_subrev_u32 v219, 19, v248
  v_subrev_u32 v220, 24, v248
  v_subrev_u32 v221, 25, v248
  v_subrev_u32 v222, 26, v248
  v_subrev_u32 v223, 27, v248
  v_ashrrev_i32 v208, 31, v208
  v_ashrrev_i32 v209, 31, v209
  v_ashrrev_i32 v210, 31, v210
  v_ashrrev_i32 v211, 31, v211
  v_ashrrev_i32 v212, 31, v212
  v_ashrrev_i32 v213, 31, v213
  v_ashrrev_i32 v214, 31, v214
  v_ashrrev_i32 v215, 31, v215
  v_ashrrev_i32 v216, 31, v216
  v_ashrrev_i32 v217, 31, v217
  v_ashrrev_i32 v218, 31, v218
  v_ashrrev_i32 v219, 31, v219
  v_ashrrev_i32 v220, 31, v220
  v_ashrrev_i32 v221, 31, v221
  v_ashrrev_i32 v222, 31, v222
  v_ashrrev_i32 v223, 31, v223
  v_bfi_b32 v240, v250, v208, v209
  v_bfi_b32 v241, v250, v210, v211
  v_bfi_b32 v242, v250, v212, v213
  v_bfi_b32 v243, v250, v214, v215
  v_bfi_b32 v244, v250, v216, v217
  v_bfi_b32 v245, v250, v218, v219
  v_bfi_b32 v246, v250, v220, v221
  v_bfi_b32 v247, v250, v222, v223
  v_and_b32 v224, v249, v208
  v_and_b32 v225, v249, v209
  v_and_b32 v226, v249, v210
  v_and_b32 v227, v249, v211
  v_and_b32 v228, v249, v212
  v_and_b32 v229, v249, v213
  v_and_b32 v230, v249, v214
  v_and_b32 v231, v249, v215
  v_and_b32 v232, v249, v216
  v_and_b32 v233, v249, v217
  v_and_b32 v234, v249, v218
  v_and_b32 v235, v249, v219
  v_and_b32 v236, v249, v220
  v_and_b32 v237, v249, v221
  v_and_b32 v238, v249, v222
  v_and_b32 v239, v249, v223
  v_xor_b32 v208, v249, v224
  v_xor_b32 v209, v249, v225
  v_xor_b32 v210, v249, v226
  v_xor_b32 v211, v249, v227
  v_xor_b32 v212, v249, v228
  v_xor_b32 v213, v249, v229
  v_xor_b32 v214, v249, v230
  v_xor_b32 v215, v249, v231
  v_xor_b32 v216, v249, v232
  v_xor_b32 v217, v249, v233
  v_xor_b32 v218, v249, v234
  v_xor_b32 v219, v249, v235
  v_xor_b32 v220, v249, v236
  v_xor_b32 v221, v249, v237
  v_xor_b32 v222, v249, v238
  v_xor_b32 v223, v249, v239
  s_cmp_lg_u32 s61, 0
  s_cbranch_scc1 L_c_nomsk
  v_lshlrev_b32 v248, 4, v1
  v_add_u32 v248, 147456, v248
  ds_write_b128 v248, v[208:211] offset:0
  ds_write_b128 v248, v[212:215] offset:1024
  ds_write_b128 v248, v[216:219] offset:2048
  ds_write_b128 v248, v[220:223] offset:3072
  ds_write_b128 v248, v[224:227] offset:4096
  ds_write_b128 v248, v[228:231] offset:5120
  ds_write_b128 v248, v[232:235] offset:6144
  ds_write_b128 v248, v[236:239] offset:7168
  ds_write_b128 v248, v[240:243] offset:8192
  ds_write_b128 v248, v[244:247] offset:9216
L_c_nomsk:
  s_nop 0
  v_lshrrev_b32 v248, 3, v1
  v_bfe_u32 v249, v248, 1, 1
  v_lshlrev_b32 v249, 2, v249
  v_and_b32 v250, 7, v1
  v_xor_b32 v249, v249, v250
  v_lshlrev_b32 v249, 4, v249
  v_lshl_add_u32 v202, v248, 10, v249
  s_lshr_b32 s66, s62, 2
  s_lshl_b32 s66, s66, 7
  s_lshl_b32 s67, s61, 16
  s_add_u32 s6, s66, s67
  s_lshl_b32 s7, s61, 13
  s_mov_b32 s56, s20
  s_and_b32 s57, s21, 0xffff
  s_mov_b32 s58, 524288
  s_mov_b32 s59, 0x00020000
  v_lshrrev_b32 v196, 1, v1
  v_lshlrev_b32 v196, 10, v196
  v_and_b32 v248, 1, v1
  v_lshl_add_u32 v196, v248, 3, v196
  s_lshr_b32 s66, s62, 4
  s_add_u32 s66, s66, 4
  s_lshl_b32 s66, s66, 2
  s_lshl_b32 s67, s63, 7
  s_add_u32 s66, s66, s67
  s_add_u32 s66, s66, 65536
  v_add_u32 v196, s66, v196
  s_call_b64 s[4:5], L_sub_b
  s_mov_b32 s68, s70
  s_mov_b32 s69, s71
  s_cmp_eq_u32 s64, 0
  s_cbranch_scc1 L_c_halo_done
  s_mov_b32 s74, 200000
L_poll_h:
  global_load_dword v158, v157, s[38:39] sc1
  s_waitcnt vmcnt(0)
  v_cmp_ne_u32 vcc, s60, v158
  s_cbranch_vccz L_poll_h_done
  s_sub_u32 s74, s74, 1
  s_cmp_lg_u32 s74, 0
  s_cbranch_scc1 L_poll_h
L_poll_h_done:
  v_lshlrev_b32 v18, 4, v1
  s_lshl_b32 s70, s72, 10
  s_mul_i32 s71, s72, 1040
  s_lshl_b32 s66, s65, 7
  s_lshl_b32 s67, s68, 2
  s_add_u32 s66, s66, s67
  s_add_u32 s66, s66, s72
  s_lshl_b32 s66, s66, 10
  s_add_u32 m0, s70, 4096
  s_add_u32 s67, s66, 1048576
  buffer_load_dwordx4 v18, s[52:55], s67 offen sc1 lds
  s_add_u32 m0, s71, 28736
  s_add_u32 s67, s66, 3145728
  buffer_load_dwordx4 v18, s[52:55], s67 offen sc1 lds
  s_add_u32 m0, s70, 16384
  s_add_u32 s67, s66, 1114112
  buffer_load_dwordx4 v18, s[52:55], s67 offen sc1 lds
  s_add_u32 m0, s71, 41216
  s_add_u32 s67, s66, 3211264
  buffer_load_dwordx4 v18, s[52:55], s67 offen sc1 lds
  s_cmp_eq_u32 s64, 1
  s_cbranch_scc1 L_c_halo_done
  s_lshl_b32 s66, s65, 7
  s_lshl_b32 s67, s69, 2
  s_add_u32 s66, s66, s67
  s_add_u32 s66, s66, s72
  s_lshl_b32 s66, s66, 10
  s_add_u32 m0, s70, 0
  s_add_u32 s67, s66, 1048576
  buffer_load_dwordx4 v18, s[52:55], s67 offen sc1 lds
  s_add_u32 m0, s71, 24576
  s_add_u32 s67, s66, 3145728
  buffer_load_dwordx4 v18, s[52:55], s67 offen sc1 lds
  s_add_u32 m0, s70, 12288
  s_add_u32 s67, s66, 1114112
  buffer_load_dwordx4 v18, s[52:55], s67 offen sc1 lds
  s_add_u32 m0, s71, 37056
  s_add_u32 s67, s66, 3211264
  buffer_load_dwordx4 v18, s[52:55], s67 offen sc1 lds
L_c_halo_done:
  s_or_b32 s66, s2, s61
  s_cmp_lg_u32 s66, 0
  s_cbranch_scc0 L_st_epoch
L_epdone:
  s_waitcnt lgkmcnt(0)
  s_barrier
  s_waitcnt vmcnt(0) lgkmcnt(0)
  s_barrier
  s_branch L_a2
L_lwave:
  v_lshrrev_b32 v220, 3, v1
  s_lshl_b32 s66, s64, 7
  s_lshl_b32 s67, s72, 5
  s_add_u32 s66, s66, s67
  v_add_u32 v220, s66, v220
  v_lshlrev_b32 v220, 10, v220
  v_and_b32 v221, 7, v1
  v_lshrrev_b32 v222, 4, v1
  v_xor_b32 v223, v221, v222
  v_lshl_add_u32 v200, v223, 4, v220
  v_xor_b32 v223, 4, v223
  v_lshl_add_u32 v201, v223, 4, v220
  v_lshrrev_b32 v220, 2, v1
  s_lshl_b32 s66, s72, 4
  v_add_u32 v220, s66, v220
  v_mul_u32_u24 v220, 3072, v220
  v_and_b32 v221, 3, v1
  v_lshlrev_b32 v221, 4, v221
  s_lshl_b32 s66, s65, 6
  v_add3_u32 v202, v220, v221, s66
  s_lshl_b32 s70, s72, 12
  s_lshl_b32 s71, s72, 10
  s_lshl_b32 s79, s63, 6
  s_lshl_b32 s67, s62, 1
  s_add_u32 s79, s79, s67
  s_lshr_b32 s67, s72, 1
  s_add_u32 s79, s79, s67
  s_mul_i32 s78, s67, 12864
  s_add_u32 s78, s78, 114688
  s_and_b32 s68, s72, 1
  s_lshl_b32 s67, s79, 12
  s_lshl_b32 s69, s68, 11
  s_add_u32 s67, s67, s69
  v_lshlrev_b32 v203, 4, v1
  v_add_u32 v203, s67, v203
  v_add_u32 v204, 2, v203
  s_waitcnt lgkmcnt(0)
  s_mov_b32 s40, s16
  s_and_b32 s41, s17, 0xffff
  s_mov_b32 s42, 2097152
  s_mov_b32 s43, 0x00020000
  s_mov_b32 s44, s18
  s_and_b32 s45, s19, 0xffff
  s_mov_b32 s46, 1572864
  s_mov_b32 s47, 0x00020000
  s_load_dword s60, s[38:39], 131072
  s_and_b32 s66, s64, 3
  s_lshl_b32 s66, s66, 1
  s_add_u32 s75, s65, s66
  s_add_u32 s67, s75, 0
  s_and_b32 s67, s67, 7
  s_mul_i32 s68, s67, 196608
  s_lshl_b32 s67, s67, 7
  s_add_u32 m0, s70, 0
  s_add_u32 s66, s67, 0
  buffer_load_dwordx4 v200, s[40:43], s66 offen  lds
  s_add_u32 m0, s70, 1024
  s_add_u32 s66, s67, 8192
  buffer_load_dwordx4 v201, s[40:43], s66 offen  lds
  s_add_u32 m0, s70, 2048
  s_add_u32 s66, s67, 16384
  buffer_load_dwordx4 v200, s[40:43], s66 offen  lds
  s_add_u32 m0, s70, 3072
  s_add_u32 s66, s67, 24576
  buffer_load_dwordx4 v201, s[40:43], s66 offen  lds
  s_add_u32 m0, s71, 16384
  s_add_u32 s66, s68, 0
  buffer_load_dwordx4 v202, s[44:47], s66 offen  lds
  s_add_u32 m0, s71, 20480
  s_add_u32 s66, s68, 1024
  buffer_load_dwordx4 v202, s[44:47], s66 offen  lds
  s_add_u32 m0, s71, 24576
  s_add_u32 s66, s68, 2048
  buffer_load_dwordx4 v202, s[44:47], s66 offen  lds
  s_add_u32 s67, s75, 1
  s_and_b32 s67, s67, 7
  s_mul_i32 s68, s67, 196608
  s_lshl_b32 s67, s67, 7
  s_add_u32 m0, s70, 28672
  s_add_u32 s66, s67, 0
  buffer_load_dwordx4 v200, s[40:43], s66 offen  lds
  s_add_u32 m0, s70, 29696
  s_add_u32 s66, s67, 8192
  buffer_load_dwordx4 v201, s[40:43], s66 offen  lds
  s_add_u32 m0, s70, 30720
  s_add_u32 s66, s67, 16384
  buffer_load_dwordx4 v200, s[40:43], s66 offen  lds
  s_add_u32 m0, s70, 31744
  s_add_u32 s66, s67, 24576
  buffer_load_dwordx4 v201, s[40:43], s66 offen  lds
  s_add_u32 m0, s71, 45056
  s_add_u32 s66, s68, 0
  buffer_load_dwordx4 v202, s[44:47], s66 offen  lds
  s_add_u32 m0, s71, 49152
  s_add_u32 s66, s68, 1024
  buffer_load_dwordx4 v202, s[44:47], s66 offen  lds
  s_add_u32 m0, s71, 53248
  s_add_u32 s66, s68, 2048
  buffer_load_dwordx4 v202, s[44:47], s66 offen  lds
  s_add_u32 s67, s75, 2
  s_and_b32 s67, s67, 7
  s_mul_i32 s68, s67, 196608
  s_lshl_b32 s67, s67, 7
  s_add_u32 m0, s70, 57344
  s_add_u32 s66, s67, 0
  buffer_load_dwordx4 v200, s[40:43], s66 offen  lds
  s_add_u32 m0, s70, 58368
  s_add_u32 s66, s67, 8192
  buffer_load_dwordx4 v201, s[40:43], s66 offen  lds
  s_add_u32 m0, s70, 59392
  s_add_u32 s66, s67, 16384
  buffer_load_dwordx4 v200, s[40:43], s66 offen  lds
  s_add_u32 m0, s70, 60416
  s_add_u32 s66, s67, 24576
  buffer_load_dwordx4 v201, s[40:43], s66 offen  lds
  s_add_u32 m0, s71, 73728
  s_add_u32 s66, s68, 0
  buffer_load_dwordx4 v202, s[44:47], s66 offen  lds
  s_add_u32 m0, s71, 77824
  s_add_u32 s66, s68, 1024
  buffer_load_dwordx4 v202, s[44:47], s66 offen  lds
  s_add_u32 m0, s71, 81920
  s_add_u32 s66, s68, 2048
  buffer_load_dwordx4 v202, s[44:47], s66 offen  lds
  s_waitcnt lgkmcnt(0)
  s_lshl_b32 s66, s72, 2
  s_add_u32 s66, s66, 163792
  v_mov_b32 v29, s66
  v_mov_b32 v26, s60
  ds_write_b32 v29, v26
  s_waitcnt lgkmcnt(0)
  s_waitcnt vmcnt(14)
  s_barrier
  s_add_u32 s67, s75, 3
  s_and_b32 s67, s67, 7
  s_mul_i32 s68, s67, 196608
  s_lshl_b32 s67, s67, 7
  s_add_u32 m0, s70, 86016
  s_add_u32 s66, s67, 0
  buffer_load_dwordx4 v200, s[40:43], s66 offen  lds
  s_add_u32 m0, s70, 87040
  s_add_u32 s66, s67, 8192
  buffer_load_dwordx4 v201, s[40:43], s66 offen  lds
  s_add_u32 m0, s70, 88064
  s_add_u32 s66, s67, 16384
  buffer_load_dwordx4 v200, s[40:43], s66 offen  lds
  s_add_u32 m0, s70, 89088
  s_add_u32 s66, s67, 24576
  buffer_load_dwordx4 v201, s[40:43], s66 offen  lds
  s_add_u32 m0, s71, 102400
  s_add_u32 s66, s68, 0
  buffer_load_dwordx4 v202, s[44:47], s66 offen  lds
  s_add_u32 m0, s71, 106496
  s_add_u32 s66, s68, 1024
  buffer_load_dwordx4 v202, s[44:47], s66 offen  lds
  s_add_u32 m0, s71, 110592
  s_add_u32 s66, s68, 2048
  buffer_load_dwordx4 v202, s[44:47], s66 offen  lds
  s_add_u32 s60, s60, 1
  s_mov_b32 s52, s38
  s_and_b32 s53, s39, 0xffff
  s_mov_b32 s54, 11534336
  s_mov_b32 s55, 0x00020000
  s_waitcnt vmcnt(14)
  s_barrier
  s_add_u32 s67, s75, 4
  s_and_b32 s67, s67, 7
  s_mul_i32 s68, s67, 196608
  s_lshl_b32 s67, s67, 7
  s_add_u32 m0, s70, 0
  s_add_u32 s66, s67, 0
  buffer_load_dwordx4 v200, s[40:43], s66 offen  lds
  s_add_u32 m0, s70, 1024
  s_add_u32 s66, s67, 8192
  buffer_load_dwordx4 v201, s[40:43], s66 offen  lds
  s_add_u32 m0, s70, 2048
  s_add_u32 s66, s67, 16384
  buffer_load_dwordx4 v200, s[40:43], s66 offen  lds
  s_add_u32 m0, s70, 3072
  s_add_u32 s66, s67, 24576
  buffer_load_dwordx4 v201, s[40:43], s66 offen  lds
  s_add_u32 m0, s71, 16384
  s_add_u32 s66, s68, 0
  buffer_load_dwordx4 v202, s[44:47], s66 offen  lds
  s_add_u32 m0, s71, 20480
  s_add_u32 s66, s68, 1024
  buffer_load_dwordx4 v202, s[44:47], s66 offen  lds
  s_add_u32 m0, s71, 24576
  s_add_u32 s66, s68, 2048
  buffer_load_dwordx4 v202, s[44:47], s66 offen  lds
  s_waitcnt vmcnt(14)
  s_barrier
  s_add_u32 s67, s75, 5
  s_and_b32 s67, s67, 7
  s_mul_i32 s68, s67, 196608
  s_lshl_b32 s67, s67, 7
  s_add_u32 m0, s70, 28672
  s_add_u32 s66, s67, 0
  buffer_load_dwordx4 v200, s[40:43], s66 offen  lds
  s_add_u32 m0, s70, 29696
  s_add_u32 s66, s67, 8192
  buffer_load_dwordx4 v201, s[40:43], s66 offen  lds
  s_add_u32 m0, s70, 30720
  s_add_u32 s66, s67, 16384
  buffer_load_dwordx4 v200, s[40:43], s66 offen  lds
  s_add_u32 m0, s70, 31744
  s_add_u32 s66, s67, 24576
  buffer_load_dwordx4 v201, s[40:43], s66 offen  lds
  s_add_u32 m0, s71, 45056
  s_add_u32 s66, s68, 0
  buffer_load_dwordx4 v202, s[44:47], s66 offen  lds
  s_add_u32 m0, s71, 49152
  s_add_u32 s66, s68, 1024
  buffer_load_dwordx4 v202, s[44:47], s66 offen  lds
  s_add_u32 m0, s71, 53248
  s_add_u32 s66, s68, 2048
  buffer_load_dwordx4 v202, s[44:47], s66 offen  lds
  s_waitcnt vmcnt(14)
  s_barrier
  s_add_u32 s67, s75, 6
  s_and_b32 s67, s67, 7
  s_mul_i32 s68, s67, 196608
  s_lshl_b32 s67, s67, 7
  s_add_u32 m0, s70, 57344
  s_add_u32 s66, s67, 0
  buffer_load_dwordx4 v200, s[40:43], s66 offen  lds
  s_add_u32 m0, s70, 58368
  s_add_u32 s66, s67, 8192
  buffer_load_dwordx4 v201, s[40:43], s66 offen  lds
  s_add_u32 m0, s70, 59392
  s_add_u32 s66, s67, 16384
  buffer_load_dwordx4 v200, s[40:43], s66 offen  lds
  s_add_u32 m0, s70, 60416
  s_add_u32 s66, s67, 24576
  buffer_load_dwordx4 v201, s[40:43], s66 offen  lds
  s_add_u32 m0, s71, 73728
  s_add_u32 s66, s68, 0
  buffer_load_dwordx4 v202, s[44:47], s66 offen  lds
  s_add_u32 m0, s71, 77824
  s_add_u32 s66, s68, 1024
  buffer_load_dwordx4 v202, s[44:47], s66 offen  lds
  s_add_u32 m0, s71, 81920
  s_add_u32 s66, s68, 2048
  buffer_load_dwordx4 v202, s[44:47], s66 offen  lds
  s_waitcnt vmcnt(14)
  s_barrier
  s_add_u32 s67, s75, 7
  s_and_b32 s67, s67, 7
  s_mul_i32 s68, s67, 196608
  s_lshl_b32 s67, s67, 7
  s_add_u32 m0, s70, 86016
  s_add_u32 s66, s67, 0
  buffer_load_dwordx4 v200, s[40:43], s66 offen  lds
  s_add_u32 m0, s70, 87040
  s_add_u32 s66, s67, 8192
  buffer_load_dwordx4 v201, s[40:43], s66 offen  lds
  s_add_u32 m0, s70, 88064
  s_add_u32 s66, s67, 16384
  buffer_load_dwordx4 v200, s[40:43], s66 offen  lds
  s_add_u32 m0, s70, 89088
  s_add_u32 s66, s67, 24576
  buffer_load_dwordx4 v201, s[40:43], s66 offen  lds
  s_add_u32 m0, s71, 102400
  s_add_u32 s66, s68, 0
  buffer_load_dwordx4 v202, s[44:47], s66 offen  lds
  s_add_u32 m0, s71, 106496
  s_add_u32 s66, s68, 1024
  buffer_load_dwordx4 v202, s[44:47], s66 offen  lds
  s_add_u32 m0, s71, 110592
  s_add_u32 s66, s68, 2048
  buffer_load_dwordx4 v202, s[44:47], s66 offen  lds
  s_waitcnt vmcnt(14)
  s_barrier
  s_lshl_b32 s66, s79, 12
  v_mov_b32 v34, s66
  global_load_dword v32, v34, s[30:31]
  s_lshl_b32 s66, s79, 1
  s_and_b32 s66, s66, 0xfffffffc
  v_mov_b32 v35, s66
  global_load_dword v33, v35, s[32:33]
  v_and_b32 v30, 31, v1
  v_lshlrev_b32 v30, 10, v30
  s_lshl_b32 s66, s63, 7
  s_lshr_b32 s67, s62, 3
  s_lshl_b32 s67, s67, 2
  s_add_u32 s66, s66, s67
  s_add_u32 s66, s66, 0
  v_add_u32 v30, s66, v30
  s_cmp_eq_u32 s72, 0
  s_cbranch_scc1 L_l_w4a
  s_lshl_b32 s66, s2, 7
  s_add_u32 s66, s66, 0
  v_mov_b32 v30, s66
L_l_w4a:
  global_load_dword v31, v30, s[38:39] sc1
  s_mov_b32 s56, s30
  s_and_b32 s57, s31, 0xffff
  s_mov_b32 s58, 2097152
  s_mov_b32 s59, 0x00020000
  s_and_b32 s68, s72, 1
  s_lshl_b32 s68, s68, 11
  s_add_u32 s68, s68, s78
  v_add_u32 v203, 4, v203
  s_add_u32 m0, s68, 4192
  s_mov_b32 s66, 0
  buffer_load_dwordx4 v203, s[56:59], s66 offen  lds
  s_add_u32 m0, s68, 32
  s_nop 0
  buffer_load_dwordx4 v204, s[56:59], s66 offen  lds
  s_add_u32 m0, s68, 5216
  s_mov_b32 s66, 1024
  buffer_load_dwordx4 v203, s[56:59], s66 offen  lds
  s_add_u32 m0, s68, 1056
  s_nop 0
  buffer_load_dwordx4 v204, s[56:59], s66 offen  lds
  s_waitcnt vmcnt(14)
  s_barrier
  v_and_b32 v25, 15, v1
  v_lshrrev_b32 v26, 4, v1
  v_lshrrev_b32 v27, 1, v25
  v_lshl_add_u32 v27, v26, 2, v27
  v_lshlrev_b32 v27, 2, v27
  v_and_b32 v28, 1, v25
  v_mul_u32_u24 v28, 4160, v28
  s_and_b32 s68, s72, 1
  s_lshl_b32 s66, s68, 8
  s_add_u32 s66, s66, s78
  v_add3_u32 v16, v27, v28, s66
  v_add_u32 v17, 512, v16
  v_add_u32 v18, 1024, v16
  v_add_u32 v19, 1536, v16
  v_add_u32 v20, 2048, v16
  v_add_u32 v21, 2560, v16
  v_add_u32 v22, 3072, v16
  v_add_u32 v23, 3584, v16
  v_lshlrev_b32 v27, 4, v26
  v_lshlrev_b32 v28, 5, v25
  v_sub_u32 v27, v27, v28
  s_add_u32 s66, s66, 8768
  v_add_u32 v24, s66, v27
  s_waitcnt vmcnt(4)
  s_mov_b32 s75, 0
  s_cmp_lg_u32 s72, 0
  s_cbranch_scc1 L_l_late
  v_cmp_ne_u32 vcc, s60, v31
  s_cbranch_vccnz L_l_late
  s_lshl_b32 s66, s79, 12
  s_add_u32 s66, s66, 7340032
  v_lshlrev_b32 v28, 4, v1
  s_mov_b32 m0, 122976
  s_add_u32 s67, s66, 0
  buffer_load_dwordx4 v28, s[52:55], s67 offen sc1 lds
  s_mov_b32 m0, 124000
  s_add_u32 s67, s66, 1024
  buffer_load_dwordx4 v28, s[52:55], s67 offen sc1 lds
  s_mov_b32 m0, 125024
  s_add_u32 s67, s66, 2048
  buffer_load_dwordx4 v28, s[52:55], s67 offen sc1 lds
  s_mov_b32 m0, 126048
  s_add_u32 s67, s66, 3072
  buffer_load_dwordx4 v28, s[52:55], s67 offen sc1 lds
  s_mov_b32 m0, 135840
  s_add_u32 s67, s66, 4096
  buffer_load_dwordx4 v28, s[52:55], s67 offen sc1 lds
  s_mov_b32 m0, 136864
  s_add_u32 s67, s66, 5120
  buffer_load_dwordx4 v28, s[52:55], s67 offen sc1 lds
  s_mov_b32 m0, 137888
  s_add_u32 s67, s66, 6144
  buffer_load_dwordx4 v28, s[52:55], s67 offen sc1 lds
  s_mov_b32 m0, 138912
  s_add_u32 s67, s66, 7168
  buffer_load_dwordx4 v28, s[52:55], s67 offen sc1 lds
  s_mov_b32 s75, 1
L_l_late:
  s_and_b32 s68, s72, 1
  s_cmp_eq_u32 s68, 0
  s_cbranch_scc1 L_l_nopad
  s_lshr_b32 s66, s72, 1
  s_lshl_b32 s66, s66, 4
  v_lshrrev_b32 v33, s66, v33
  v_lshlrev_b32 v33, 16, v33
  v_lshlrev_b32 v34, 16, v32
  v_add_f32 v34, v33, v34
  v_cvt_pk_bf16_f32 v34, v34, v34
  v_and_b32 v34, 0xffff, v34
  v_and_b32 v35, 0xffff0000, v32
  v_or_b32 v35, v35, v34
  v_lshlrev_b32 v34, 16, v34
  v_mov_b32 v36, 0
  v_lshlrev_b32 v37, 2, v1
  v_add_u32 v37, s78, v37
  v_cmp_eq_u32 vcc, 7, v1
  s_nop 1
  v_cndmask_b32 v34, v36, v34, vcc
  v_cndmask_b32 v35, v36, v35, vcc
  v_cmp_gt_u32 vcc, 8, v1
  s_nop 3
  s_and_saveexec_b64 s[76:77], vcc
  ds_write_b32 v37, v34 offset:0
  ds_write_b32 v37, v35 offset:4160
  s_mov_b64 exec, s[76:77]
  v_mov_b32 v39, 0
  v_mov_b32 v38, 0
  v_lshlrev_b32 v37, 3, v1
  v_add_u32 v37, s78, v37
  v_cmp_gt_u32 vcc, 60, v1
  s_nop 3
  s_and_saveexec_b64 s[76:77], vcc
  ds_write_b64 v37, v[38:39] offset:12384
  s_mov_b64 exec, s[76:77]
L_l_nopad:
  s_waitcnt lgkmcnt(0)
  s_barrier
  v_mov_b32 v196, 0
  s_call_b64 s[4:5], L_sub_b
  s_cmp_lg_u32 s72, 0
  s_cbranch_scc1 L_l_have
  s_cmp_eq_u32 s75, 1
  s_cbranch_scc1 L_l_have
  s_mov_b32 s74, 200000
L_poll_b1:
  global_load_dword v31, v30, s[38:39] sc1
  s_waitcnt vmcnt(0)
  v_cmp_ne_u32 vcc, s60, v31
  s_cbranch_vccz L_poll_b1_done
  s_sub_u32 s74, s74, 1
  s_cmp_lg_u32 s74, 0
  s_cbranch_scc1 L_poll_b1
L_poll_b1_done:
  s_lshl_b32 s66, s79, 12
  s_add_u32 s66, s66, 7340032
  v_lshlrev_b32 v28, 4, v1
  s_mov_b32 m0, 122976
  s_add_u32 s67, s66, 0
  buffer_load_dwordx4 v28, s[52:55], s67 offen sc1 lds
  s_mov_b32 m0, 124000
  s_add_u32 s67, s66, 1024
  buffer_load_dwordx4 v28, s[52:55], s67 offen sc1 lds
  s_mov_b32 m0, 125024
  s_add_u32 s67, s66, 2048
  buffer_load_dwordx4 v28, s[52:55], s67 offen sc1 lds
  s_mov_b32 m0, 126048
  s_add_u32 s67, s66, 3072
  buffer_load_dwordx4 v28, s[52:55], s67 offen sc1 lds
  s_mov_b32 m0, 135840
  s_add_u32 s67, s66, 4096
  buffer_load_dwordx4 v28, s[52:55], s67 offen sc1 lds
  s_mov_b32 m0, 136864
  s_add_u32 s67, s66, 5120
  buffer_load_dwordx4 v28, s[52:55], s67 offen sc1 lds
  s_mov_b32 m0, 137888
  s_add_u32 s67, s66, 6144
  buffer_load_dwordx4 v28, s[52:55], s67 offen sc1 lds
  s_mov_b32 m0, 138912
  s_add_u32 s67, s66, 7168
  buffer_load_dwordx4 v28, s[52:55], s67 offen sc1 lds
L_l_have:
  s_waitcnt vmcnt(0)
  v_mov_b32 v26, s60
  ds_write_b32 v29, v26
  v_mov_b32 v25, 163792
  s_mov_b32 s74, 1600000
L_l_ospin:
  ds_read_b128 v[32:35], v25
  s_waitcnt lgkmcnt(0)
  v_cmp_ne_u32 vcc, s60, v32
  v_cmp_ne_u32 s[80:81], s60, v33
  v_cmp_ne_u32 s[82:83], s60, v34
  v_cmp_ne_u32 s[84:85], s60, v35
  s_nop 1
  s_or_b64 vcc, vcc, s[80:81]
  s_or_b64 vcc, vcc, s[82:83]
  s_or_b64 vcc, vcc, s[84:85]
  s_cbranch_vccz L_l_go
  s_sub_u32 s74, s74, 1
  s_cmp_lg_u32 s74, 0
  s_cbranch_scc1 L_l_ospin
L_l_go:
  s_and_b32 s68, s72, 1
  ds_read2_b32 v[32:33], v16 offset0:0 offset1:1
  ds_read2_b32 v[34:35], v16 offset0:2 offset1:3
  ds_read_b128 v[96:99], v24 offset:3584
  ds_read_b128 v[100:103], v24 offset:3072
  ds_read_b128 v[104:107], v24 offset:2560
  ds_read_b128 v[108:111], v24 offset:2048
  ds_read_b128 v[112:115], v24 offset:1536
  ds_read_b128 v[116:119], v24 offset:1024
  ds_read_b128 v[120:123], v24 offset:512
  ds_read_b128 v[124:127], v24 offset:0
  ds_read2_b32 v[36:37], v17 offset0:0 offset1:1
  ds_read2_b32 v[38:39], v17 offset0:2 offset1:3
  ds_read2_b32 v[40:41], v18 offset0:0 offset1:1
  ds_read2_b32 v[42:43], v18 offset0:2 offset1:3
  ds_read2_b32 v[44:45], v19 offset0:0 offset1:1
  ds_read2_b32 v[46:47], v19 offset0:2 offset1:3
  ds_read2_b32 v[48:49], v20 offset0:0 offset1:1
  ds_read2_b32 v[50:51], v20 offset0:2 offset1:3
  ds_read2_b32 v[52:53], v21 offset0:0 offset1:1
  ds_read2_b32 v[54:55], v21 offset0:2 offset1:3
  ds_read2_b32 v[56:57], v22 offset0:0 offset1:1
  ds_read2_b32 v[58:59], v22 offset0:2 offset1:3
  ds_read2_b32 v[60:61], v23 offset0:0 offset1:1
  ds_read2_b32 v[62:63], v23 offset0:2 offset1:3
  s_waitcnt lgkmcnt(14)
  v_mfma_f32_16x16x32_bf16 v[160:163], v[32:35], v[96:99], 0
  v_mfma_f32_16x16x32_bf16 v[164:167], v[32:35], v[100:103], 0
  v_mfma_f32_16x16x32_bf16 v[168:171], v[32:35], v[104:107], 0
  v_mfma_f32_16x16x32_bf16 v[172:175], v[32:35], v[108:111], 0
  v_mfma_f32_16x16x32_bf16 v[176:179], v[32:35], v[112:115], 0
  v_mfma_f32_16x16x32_bf16 v[180:183], v[32:35], v[116:119], 0
  v_mfma_f32_16x16x32_bf16 v[184:187], v[32:35], v[120:123], 0
  v_mfma_f32_16x16x32_bf16 v[188:191], v[32:35], v[124:127], 0
  s_waitcnt lgkmcnt(0)
  v_mfma_f32_16x16x32_bf16 v[164:167], v[36:39], v[96:99], v[164:167]
  ds_read_b128 v[128:131], v24 offset:3648
  v_mfma_f32_16x16x32_bf16 v[168:171], v[36:39], v[100:103], v[168:171]
  ds_read2_b32 v[64:65], v16 offset0:16 offset1:17
  v_mfma_f32_16x16x32_bf16 v[172:175], v[36:39], v[104:107], v[172:175]
  ds_read2_b32 v[66:67], v16 offset0:18 offset1:19
  v_mfma_f32_16x16x32_bf16 v[176:179], v[36:39], v[108:111], v[176:179]
  ds_read_b128 v[132:135], v24 offset:3136
  v_mfma_f32_16x16x32_bf16 v[180:183], v[36:39], v[112:115], v[180:183]
  ds_read2_b32 v[68:69], v17 offset0:16 offset1:17
  v_mfma_f32_16x16x32_bf16 v[184:187], v[36:39], v[116:119], v[184:187]
  ds_read2_b32 v[70:71], v17 offset0:18 offset1:19
  v_mfma_f32_16x16x32_bf16 v[188:191], v[36:39], v[120:123], v[188:191]
  ds_read_b128 v[136:139], v24 offset:2624
  v_mfma_f32_16x16x32_bf16 v[168:171], v[40:43], v[96:99], v[168:171]
  ds_read2_b32 v[72:73], v18 offset0:16 offset1:17
  v_mfma_f32_16x16x32_bf16 v[172:175], v[40:43], v[100:103], v[172:175]
  ds_read2_b32 v[74:75], v18 offset0:18 offset1:19
  v_mfma_f32_16x16x32_bf16 v[176:179], v[40:43], v[104:107], v[176:179]
  ds_read_b128 v[140:143], v24 offset:2112
  v_mfma_f32_16x16x32_bf16 v[180:183], v[40:43], v[108:111], v[180:183]
  ds_read2_b32 v[76:77], v19 offset0:16 offset1:17
  v_mfma_f32_16x16x32_bf16 v[184:187], v[40:43], v[112:115], v[184:187]
  ds_read2_b32 v[78:79], v19 offset0:18 offset1:19
  v_mfma_f32_16x16x32_bf16 v[188:191], v[40:43], v[116:119], v[188:191]
  ds_read_b128 v[144:147], v24 offset:1600
  v_mfma_f32_16x16x32_bf16 v[172:175], v[44:47], v[96:99], v[172:175]
  ds_read2_b32 v[80:81], v20 offset0:16 offset1:17
  v_mfma_f32_16x16x32_bf16 v[176:179], v[44:47], v[100:103], v[176:179]
  ds_read2_b32 v[82:83], v20 offset0:18 offset1:19
  v_mfma_f32_16x16x32_bf16 v[180:183], v[44:47], v[104:107], v[180:183]
  ds_read_b128 v[148:151], v24 offset:1088
  v_mfma_f32_16x16x32_bf16 v[184:187], v[44:47], v[108:111], v[184:187]
  ds_read2_b32 v[84:85], v21 offset0:16 offset1:17
  v_mfma_f32_16x16x32_bf16 v[188:191], v[44:47], v[112:115], v[188:191]
  ds_read2_b32 v[86:87], v21 offset0:18 offset1:19
  v_mfma_f32_16x16x32_bf16 v[176:179], v[48:51], v[96:99], v[176:179]
  ds_read_b128 v[152:155], v24 offset:576
  v_mfma_f32_16x16x32_bf16 v[180:183], v[48:51], v[100:103], v[180:183]
  ds_read2_b32 v[88:89], v22 offset0:16 offset1:17
  v_mfma_f32_16x16x32_bf16 v[184:187], v[48:51], v[104:107], v[184:187]
  ds_read2_b32 v[90:91], v22 offset0:18 offset1:19
  v_mfma_f32_16x16x32_bf16 v[188:191], v[48:51], v[108:111], v[188:191]
  ds_read_b128 v[156:159], v24 offset:64
  v_mfma_f32_16x16x32_bf16 v[180:183], v[52:55], v[96:99], v[180:183]
  ds_read2_b32 v[92:93], v23 offset0:16 offset1:17
  v_mfma_f32_16x16x32_bf16 v[184:187], v[52:55], v[100:103], v[184:187]
  ds_read2_b32 v[94:95], v23 offset0:18 offset1:19
  v_mfma_f32_16x16x32_bf16 v[188:191], v[52:55], v[104:107], v[188:191]
  v_mfma_f32_16x16x32_bf16 v[184:187], v[56:59], v[96:99], v[184:187]
  v_mfma_f32_16x16x32_bf16 v[188:191], v[56:59], v[100:103], v[188:191]
  v_mfma_f32_16x16x32_bf16 v[188:191], v[60:63], v[96:99], v[188:191]
  s_waitcnt lgkmcnt(0)
  v_mfma_f32_16x16x32_bf16 v[160:163], v[64:67], v[128:131], v[160:163]
  ds_read_b128 v[96:99], v24 offset:3712
  v_mfma_f32_16x16x32_bf16 v[164:167], v[64:67], v[132:135], v[164:167]
  ds_read2_b32 v[32:33], v16 offset0:32 offset1:33
  v_mfma_f32_16x16x32_bf16 v[168:171], v[64:67], v[136:139], v[168:171]
  ds_read2_b32 v[34:35], v16 offset0:34 offset1:35
  v_mfma_f32_16x16x32_bf16 v[172:175], v[64:67], v[140:143], v[172:175]
  ds_read_b128 v[100:103], v24 offset:3200
  v_mfma_f32_16x16x32_bf16 v[176:179], v[64:67], v[144:147], v[176:179]
  ds_read2_b32 v[36:37], v17 offset0:32 offset1:33
  v_mfma_f32_16x16x32_bf16 v[180:183], v[64:67], v[148:151], v[180:183]
  ds_read2_b32 v[38:39], v17 offset0:34 offset1:35
  v_mfma_f32_16x16x32_bf16 v[184:187], v[64:67], v[152:155], v[184:187]
  ds_read_b128 v[104:107], v24 offset:2688
  v_mfma_f32_16x16x32_bf16 v[188:191], v[64:67], v[156:159], v[188:191]
  ds_read2_b32 v[40:41], v18 offset0:32 offset1:33
  v_mfma_f32_16x16x32_bf16 v[164:167], v[68:71], v[128:131], v[164:167]
  ds_read2_b32 v[42:43], v18 offset0:34 offset1:35
  v_mfma_f32_16x16x32_bf16 v[168:171], v[68:71], v[132:135], v[168:171]
  ds_read_b128 v[108:111], v24 offset:2176
  v_mfma_f32_16x16x32_bf16 v[172:175], v[68:71], v[136:139], v[172:175]
  ds_read2_b32 v[44:45], v19 offset0:32 offset1:33
  v_mfma_f32_16x16x32_bf16 v[176:179], v[68:71], v[140:143], v[176:179]
  ds_read2_b32 v[46:47], v19 offset0:34 offset1:35
  v_mfma_f32_16x16x32_bf16 v[180:183], v[68:71], v[144:147], v[180:183]
  ds_read_b128 v[112:115], v24 offset:1664
  v_mfma_f32_16x16x32_bf16 v[184:187], v[68:71], v[148:151], v[184:187]
  ds_read2_b32 v[48:49], v20 offset0:32 offset1:33
  v_mfma_f32_16x16x32_bf16 v[188:191], v[68:71], v[152:155], v[188:191]
  ds_read2_b32 v[50:51], v20 offset0:34 offset1:35
  v_mfma_f32_16x16x32_bf16 v[168:171], v[72:75], v[128:131], v[168:171]
  ds_read_b128 v[116:119], v24 offset:1152
  v_mfma_f32_16x16x32_bf16 v[172:175], v[72:75], v[132:135], v[172:175]
  ds_read2_b32 v[52:53], v21 offset0:32 offset1:33
  v_mfma_f32_16x16x32_bf16 v[176:179], v[72:75], v[136:139], v[176:179]
  ds_read2_b32 v[54:55], v21 offset0:34 offset1:35
  v_mfma_f32_16x16x32_bf16 v[180:183], v[72:75], v[140:143], v[180:183]
  ds_read_b128 v[120:123], v24 offset:640
  v_mfma_f32_16x16x32_bf16 v[184:187], v[72:75], v[144:147], v[184:187]
  ds_read2_b32 v[56:57], v22 offset0:32 offset1:33
  v_mfma_f32_16x16x32_bf16 v[188:191], v[72:75], v[148:151], v[188:191]
  ds_read2_b32 v[58:59], v22 offset0:34 offset1:35
  v_mfma_f32_16x16x32_bf16 v[172:175], v[76:79], v[128:131], v[172:175]
  ds_read_b128 v[124:127], v24 offset:128
  v_mfma_f32_16x16x32_bf16 v[176:179], v[76:79], v[132:135], v[176:179]
  ds_read2_b32 v[60:61], v23 offset0:32 offset1:33
  v_mfma_f32_16x16x32_bf16 v[180:183], v[76:79], v[136:139], v[180:183]
  ds_read2_b32 v[62:63], v23 offset0:34 offset1:35
  v_mfma_f32_16x16x32_bf16 v[184:187], v[76:79], v[140:143], v[184:187]
  v_mfma_f32_16x16x32_bf16 v[188:191], v[76:79], v[144:147], v[188:191]
  v_mfma_f32_16x16x32_bf16 v[176:179], v[80:83], v[128:131], v[176:179]
  v_mfma_f32_16x16x32_bf16 v[180:183], v[80:83], v[132:135], v[180:183]
  v_mfma_f32_16x16x32_bf16 v[184:187], v[80:83], v[136:139], v[184:187]
  v_mfma_f32_16x16x32_bf16 v[188:191], v[80:83], v[140:143], v[188:191]
  v_mfma_f32_16x16x32_bf16 v[180:183], v[84:87], v[128:131], v[180:183]
  v_mfma_f32_16x16x32_bf16 v[184:187], v[84:87], v[132:135], v[184:187]
  v_mfma_f32_16x16x32_bf16 v[188:191], v[84:87], v[136:139], v[188:191]
  v_mfma_f32_16x16x32_bf16 v[184:187], v[88:91], v[128:131], v[184:187]
  v_mfma_f32_16x16x32_bf16 v[188:191], v[88:91], v[132:135], v[188:191]
  v_mfma_f32_16x16x32_bf16 v[188:191], v[92:95], v[128:131], v[188:191]
  s_waitcnt lgkmcnt(0)
  v_mfma_f32_16x16x32_bf16 v[160:163], v[32:35], v[96:99], v[160:163]
  ds_read_b128 v[128:131], v24 offset:3776
  v_mfma_f32_16x16x32_bf16 v[164:167], v[32:35], v[100:103], v[164:167]
  ds_read2_b32 v[64:65], v16 offset0:48 offset1:49
  v_mfma_f32_16x16x32_bf16 v[168:171], v[32:35], v[104:107], v[168:171]
  ds_read2_b32 v[66:67], v16 offset0:50 offset1:51
  v_mfma_f32_16x16x32_bf16 v[172:175], v[32:35], v[108:111], v[172:175]
  ds_read_b128 v[132:135], v24 offset:3264
  v_mfma_f32_16x16x32_bf16 v[176:179], v[32:35], v[112:115], v[176:179]
  ds_read2_b32 v[68:69], v17 offset0:48 offset1:49
  v_mfma_f32_16x16x32_bf16 v[180:183], v[32:35], v[116:119], v[180:183]
  ds_read2_b32 v[70:71], v17 offset0:50 offset1:51
  v_mfma_f32_16x16x32_bf16 v[184:187], v[32:35], v[120:123], v[184:187]
  ds_read_b128 v[136:139], v24 offset:2752
  v_mfma_f32_16x16x32_bf16 v[188:191], v[32:35], v[124:127], v[188:191]
  ds_read2_b32 v[72:73], v18 offset0:48 offset1:49
  v_mfma_f32_16x16x32_bf16 v[164:167], v[36:39], v[96:99], v[164:167]
  ds_read2_b32 v[74:75], v18 offset0:50 offset1:51
  v_mfma_f32_16x16x32_bf16 v[168:171], v[36:39], v[100:103], v[168:171]
  ds_read_b128 v[140:143], v24 offset:2240
  v_mfma_f32_16x16x32_bf16 v[172:175], v[36:39], v[104:107], v[172:175]
  ds_read2_b32 v[76:77], v19 offset0:48 offset1:49
  v_mfma_f32_16x16x32_bf16 v[176:179], v[36:39], v[108:111], v[176:179]
  ds_read2_b32 v[78:79], v19 offset0:50 offset1:51
  v_mfma_f32_16x16x32_bf16 v[180:183], v[36:39], v[112:115], v[180:183]
  ds_read_b128 v[144:147], v24 offset:1728
  v_mfma_f32_16x16x32_bf16 v[184:187], v[36:39], v[116:119], v[184:187]
  ds_read2_b32 v[80:81], v20 offset0:48 offset1:49
  v_mfma_f32_16x16x32_bf16 v[188:191], v[36:39], v[120:123], v[188:191]
  ds_read2_b32 v[82:83], v20 offset0:50 offset1:51
  v_mfma_f32_16x16x32_bf16 v[168:171], v[40:43], v[96:99], v[168:171]
  ds_read_b128 v[148:151], v24 offset:1216
  v_mfma_f32_16x16x32_bf16 v[172:175], v[40:43], v[100:103], v[172:175]
  ds_read2_b32 v[84:85], v21 offset0:48 offset1:49
  v_mfma_f32_16x16x32_bf16 v[176:179], v[40:43], v[104:107], v[176:179]
  ds_read2_b32 v[86:87], v21 offset0:50 offset1:51
  v_mfma_f32_16x16x32_bf16 v[180:183], v[40:43], v[108:111], v[180:183]
  ds_read_b128 v[152:155], v24 offset:704
  v_mfma_f32_16x16x32_bf16 v[184:187], v[40:43], v[112:115], v[184:187]
  ds_read2_b32 v[88:89], v22 offset0:48 offset1:49
  v_mfma_f32_16x16x32_bf16 v[188:191], v[40:43], v[116:119], v[188:191]
  ds_read2_b32 v[90:91], v22 offset0:50 offset1:51
  v_mfma_f32_16x16x32_bf16 v[172:175], v[44:47], v[96:99], v[172:175]
  ds_read_b128 v[156:159], v24 offset:192
  v_mfma_f32_16x16x32_bf16 v[176:179], v[44:47], v[100:103], v[176:179]
  ds_read2_b32 v[92:93], v23 offset0:48 offset1:49
  v_mfma_f32_16x16x32_bf16 v[180:183], v[44:47], v[104:107], v[180:183]
  ds_read2_b32 v[94:95], v23 offset0:50 offset1:51
  v_mfma_f32_16x16x32_bf16 v[184:187], v[44:47], v[108:111], v[184:187]
  v_mfma_f32_16x16x32_bf16 v[188:191], v[44:47], v[112:115], v[188:191]
  v_mfma_f32_16x16x32_bf16 v[176:179], v[48:51], v[96:99], v[176:179]
  v_mfma_f32_16x16x32_bf16 v[180:183], v[48:51], v[100:103], v[180:183]
  v_mfma_f32_16x16x32_bf16 v[184:187], v[48:51], v[104:107], v[184:187]
  v_mfma_f32_16x16x32_bf16 v[188:191], v[48:51], v[108:111], v[188:191]
  v_mfma_f32_16x16x32_bf16 v[180:183], v[52:55], v[96:99], v[180:183]
  v_mfma_f32_16x16x32_bf16 v[184:187], v[52:55], v[100:103], v[184:187]
  v_mfma_f32_16x16x32_bf16 v[188:191], v[52:55], v[104:107], v[188:191]
  v_mfma_f32_16x16x32_bf16 v[184:187], v[56:59], v[96:99], v[184:187]
  v_mfma_f32_16x16x32_bf16 v[188:191], v[56:59], v[100:103], v[188:191]
  v_mfma_f32_16x16x32_bf16 v[188:191], v[60:63], v[96:99], v[188:191]
  s_waitcnt lgkmcnt(0)
  v_mfma_f32_16x16x32_bf16 v[160:163], v[64:67], v[128:131], v[160:163]
  v_mfma_f32_16x16x32_bf16 v[164:167], v[64:67], v[132:135], v[164:167]
  v_mfma_f32_16x16x32_bf16 v[168:171], v[64:67], v[136:139], v[168:171]
  v_mfma_f32_16x16x32_bf16 v[172:175], v[64:67], v[140:143], v[172:175]
  v_mfma_f32_16x16x32_bf16 v[176:179], v[64:67], v[144:147], v[176:179]
  v_mfma_f32_16x16x32_bf16 v[180:183], v[64:67], v[148:151], v[180:183]
  v_mfma_f32_16x16x32_bf16 v[184:187], v[64:67], v[152:155], v[184:187]
  v_mfma_f32_16x16x32_bf16 v[188:191], v[64:67], v[156:159], v[188:191]
  v_mfma_f32_16x16x32_bf16 v[164:167], v[68:71], v[128:131], v[164:167]
  v_mfma_f32_16x16x32_bf16 v[168:171], v[68:71], v[132:135], v[168:171]
  v_mfma_f32_16x16x32_bf16 v[172:175], v[68:71], v[136:139], v[172:175]
  v_mfma_f32_16x16x32_bf16 v[176:179], v[68:71], v[140:143], v[176:179]
  v_mfma_f32_16x16x32_bf16 v[180:183], v[68:71], v[144:147], v[180:183]
  v_mfma_f32_16x16x32_bf16 v[184:187], v[68:71], v[148:151], v[184:187]
  v_mfma_f32_16x16x32_bf16 v[188:191], v[68:71], v[152:155], v[188:191]
  v_mfma_f32_16x16x32_bf16 v[168:171], v[72:75], v[128:131], v[168:171]
  v_mfma_f32_16x16x32_bf16 v[172:175], v[72:75], v[132:135], v[172:175]
  v_mfma_f32_16x16x32_bf16 v[176:179], v[72:75], v[136:139], v[176:179]
  v_mfma_f32_16x16x32_bf16 v[180:183], v[72:75], v[140:143], v[180:183]
  v_mfma_f32_16x16x32_bf16 v[184:187], v[72:75], v[144:147], v[184:187]
  v_mfma_f32_16x16x32_bf16 v[188:191], v[72:75], v[148:151], v[188:191]
  v_mfma_f32_16x16x32_bf16 v[172:175], v[76:79], v[128:131], v[172:175]
  v_mfma_f32_16x16x32_bf16 v[176:179], v[76:79], v[132:135], v[176:179]
  v_mfma_f32_16x16x32_bf16 v[180:183], v[76:79], v[136:139], v[180:183]
  v_mfma_f32_16x16x32_bf16 v[184:187], v[76:79], v[140:143], v[184:187]
  v_mfma_f32_16x16x32_bf16 v[188:191], v[76:79], v[144:147], v[188:191]
  v_mfma_f32_16x16x32_bf16 v[176:179], v[80:83], v[128:131], v[176:179]
  v_mfma_f32_16x16x32_bf16 v[180:183], v[80:83], v[132:135], v[180:183]
  v_mfma_f32_16x16x32_bf16 v[184:187], v[80:83], v[136:139], v[184:187]
  v_mfma_f32_16x16x32_bf16 v[188:191], v[80:83], v[140:143], v[188:191]
  v_mfma_f32_16x16x32_bf16 v[180:183], v[84:87], v[128:131], v[180:183]
  v_mfma_f32_16x16x32_bf16 v[184:187], v[84:87], v[132:135], v[184:187]
  v_mfma_f32_16x16x32_bf16 v[188:191], v[84:87], v[136:139], v[188:191]
  v_mfma_f32_16x16x32_bf16 v[184:187], v[88:91], v[128:131], v[184:187]
  v_mfma_f32_16x16x32_bf16 v[188:191], v[88:91], v[132:135], v[188:191]
  v_mfma_f32_16x16x32_bf16 v[188:191], v[92:95], v[128:131], v[188:191]
  s_nop 7
  s_and_b32 s68, s72, 1
  v_and_b32 v28, 15, v1
  v_lshlrev_b32 v28, 5, v28
  v_bfe_u32 v29, v1, 4, 1
  v_lshl_add_u32 v28, v29, 9, v28
  v_lshrrev_b32 v29, 5, v1
  v_lshl_add_u32 v28, v29, 4, v28
  s_lshl_b32 s66, s79, 12
  s_lshl_b32 s67, s68, 11
  s_add_u32 s66, s66, s67
  s_add_u32 s66, s66, 9437184
  v_add_u32 v28, s66, v28
  v_lshlrev_b32 v248, 4, v1
  v_add_u32 v248, 147456, v248
  v_lshlrev_b32 v25, 4, v1
  s_lshl_b32 s66, s72, 12
  v_add_u32 v26, s66, v25
  s_xor_b32 s66, s66, 4096
  v_add_u32 v27, s66, v25
  s_cmp_lg_u32 s68, 0
  s_cbranch_scc1 L_l_x1
  ds_write_b128 v26, v[176:179] offset:57728
  ds_write_b128 v26, v[180:183] offset:58752
  ds_write_b128 v26, v[184:187] offset:59776
  ds_write_b128 v26, v[188:191] offset:60800
  s_waitcnt lgkmcnt(0)
  s_barrier
  ds_read_b128 v[32:35], v27 offset:57728
  ds_read_b128 v[36:39], v27 offset:58752
  ds_read_b128 v[40:43], v27 offset:59776
  ds_read_b128 v[44:47], v27 offset:60800
  ds_read_b128 v[208:211], v248 offset:0
  ds_read_b128 v[212:215], v248 offset:1024
  ds_read_b128 v[216:219], v248 offset:2048
  ds_read_b128 v[220:223], v248 offset:3072
  ds_read_b128 v[224:227], v248 offset:4096
  ds_read_b128 v[228:231], v248 offset:5120
  ds_read_b128 v[232:235], v248 offset:6144
  ds_read_b128 v[236:239], v248 offset:7168
  ds_read_b128 v[240:243], v248 offset:8192
  ds_read_b128 v[244:247], v248 offset:9216
  s_waitcnt lgkmcnt(10)
  v_add_f32 v48, v32, v160
  v_add_f32 v49, v33, v161
  v_add_f32 v50, v34, v162
  v_add_f32 v51, v35, v163
  v_add_f32 v52, v36, v164
  v_add_f32 v53, v37, v165
  v_add_f32 v54, v38, v166
  v_add_f32 v55, v39, v167
  v_add_f32 v56, v40, v168
  v_add_f32 v57, v41, v169
  v_add_f32 v58, v42, v170
  v_add_f32 v59, v43, v171
  v_add_f32 v60, v44, v172
  v_add_f32 v61, v45, v173
  v_add_f32 v62, v46, v174
  v_add_f32 v63, v47, v175
  s_branch L_l_x2
L_l_x1:
  s_nop 7
  ds_write_b128 v26, v[160:163] offset:57728
  ds_write_b128 v26, v[164:167] offset:58752
  ds_write_b128 v26, v[168:171] offset:59776
  ds_write_b128 v26, v[172:175] offset:60800
  s_waitcnt lgkmcnt(0)
  s_barrier
  ds_read_b128 v[32:35], v27 offset:57728
  ds_read_b128 v[36:39], v27 offset:58752
  ds_read_b128 v[40:43], v27 offset:59776
  ds_read_b128 v[44:47], v27 offset:60800
  ds_read_b128 v[208:211], v248 offset:0
  ds_read_b128 v[212:215], v248 offset:1024
  ds_read_b128 v[216:219], v248 offset:2048
  ds_read_b128 v[220:223], v248 offset:3072
  ds_read_b128 v[224:227], v248 offset:4096
  ds_read_b128 v[228:231], v248 offset:5120
  ds_read_b128 v[232:235], v248 offset:6144
  ds_read_b128 v[236:239], v248 offset:7168
  ds_read_b128 v[240:243], v248 offset:8192
  ds_read_b128 v[244:247], v248 offset:9216
  s_waitcnt lgkmcnt(10)
  v_add_f32 v48, v32, v176
  v_add_f32 v49, v33, v177
  v_add_f32 v50, v34, v178
  v_add_f32 v51, v35, v179
  v_add_f32 v52, v36, v180
  v_add_f32 v53, v37, v181
  v_add_f32 v54, v38, v182
  v_add_f32 v55, v39, v183
  v_add_f32 v56, v40, v184
  v_add_f32 v57, v41, v185
  v_add_f32 v58, v42, v186
  v_add_f32 v59, v43, v187
  v_add_f32 v60, v44, v188
  v_add_f32 v61, v45, v189
  v_add_f32 v62, v46, v190
  v_add_f32 v63, v47, v191
L_l_x2:
  v_cvt_pk_bf16_f32 v32, v48, v49
  v_cvt_pk_bf16_f32 v33, v50, v51
  v_cvt_pk_bf16_f32 v34, v52, v53
  v_cvt_pk_bf16_f32 v35, v54, v55
  v_cvt_pk_bf16_f32 v36, v56, v57
  v_cvt_pk_bf16_f32 v37, v58, v59
  v_cvt_pk_bf16_f32 v38, v60, v61
  v_cvt_pk_bf16_f32 v39, v62, v63
  v_permlane16_swap_b32 v32, v34
  v_permlane16_swap_b32 v33, v35
  v_permlane16_swap_b32 v36, v38
  v_permlane16_swap_b32 v37, v39
  global_store_dwordx4 v28, v[32:35], s[38:39] sc1
  global_store_dwordx4 v28, v[36:39], s[38:39] offset:1024 sc1
  s_waitcnt lgkmcnt(0)
  s_barrier
L_a2:
  ds_read_b128 v[16:19], v195 offset:49536
  ds_read_b128 v[52:55], v192 offset:8192
  ds_read_b128 v[20:23], v192 offset:0
  ds_read_b128 v[48:51], v192 offset:7168
  ds_read_b128 v[44:47], v192 offset:6144
  ds_read_b128 v[40:43], v192 offset:5120
  ds_read_b128 v[36:39], v192 offset:4096
  ds_read_b128 v[32:35], v192 offset:3072
  ds_read_b128 v[28:31], v192 offset:2048
  ds_read_b128 v[24:27], v192 offset:1024
  global_load_dword v160, v207, s[22:23] offset:0
  global_load_dword v161, v207, s[22:23] offset:1024
  global_load_dword v162, v207, s[22:23] offset:2048
  global_load_dword v163, v207, s[22:23] offset:3072
  s_waitcnt lgkmcnt(7)
  v_mfma_f32_32x32x16_bf16 v[224:239], v[52:55], v[16:19], v[224:239]
  v_mfma_f32_32x32x16_bf16 v[208:223], v[20:23], v[16:19], v[208:223]
  s_waitcnt lgkmcnt(5)
  v_mfma_f32_32x32x16_bf16 v[56:71], v[48:51], v[16:19], 0
  v_mfma_f32_32x32x16_bf16 v[72:87], v[44:47], v[16:19], 0
  s_cmp_gt_u32 s73, 0
  s_cbranch_scc1 L_st_nomerge
  s_nop 6
  v_max_f32 v224, v208, v224
  v_max_f32 v225, v209, v225
  v_max_f32 v226, v210, v226
  v_max_f32 v227, v211, v227
  v_max_f32 v228, v212, v228
  v_max_f32 v229, v213, v229
  v_max_f32 v230, v214, v230
  v_max_f32 v231, v215, v231
  v_max_f32 v232, v216, v232
  v_max_f32 v233, v217, v233
  v_max_f32 v234, v218, v234
  v_max_f32 v235, v219, v235
  v_max_f32 v236, v220, v236
  v_max_f32 v237, v221, v237
  v_max_f32 v238, v222, v238
  v_max_f32 v239, v223, v239
L_a2_nomerge:
  v_max_f32 v155, v224, v225
  v_max_f32 v169, v226, v227
  v_max3_f32 v155, v155, v228, v229
  v_max3_f32 v169, v169, v230, v231
  v_max3_f32 v155, v155, v232, v233
  v_max3_f32 v169, v169, v234, v235
  v_max3_f32 v155, v155, v236, v237
  v_max3_f32 v169, v169, v238, v239
  s_waitcnt lgkmcnt(0)
  s_cmp_gt_u32 s73, 7
  s_cbranch_scc1 L_a2_p1done
  v_max3_f32 v155, v155, v56, v57
  v_max3_f32 v169, v169, v58, v59
  v_max3_f32 v155, v155, v60, v61
  v_max3_f32 v169, v169, v62, v63
  v_max3_f32 v155, v155, v64, v65
  v_max3_f32 v169, v169, v66, v67
  v_max3_f32 v155, v155, v68, v69
  v_max3_f32 v169, v169, v70, v71
  v_mfma_f32_32x32x16_bf16 v[56:71], v[40:43], v[16:19], 0
  s_cmp_gt_u32 s73, 6
  s_cbranch_scc1 L_a2_p1done
  v_max3_f32 v155, v155, v72, v73
  v_max3_f32 v169, v169, v74, v75
  v_max3_f32 v155, v155, v76, v77
  v_max3_f32 v169, v169, v78, v79
  v_max3_f32 v155, v155, v80, v81
  v_max3_f32 v169, v169, v82, v83
  v_max3_f32 v155, v155, v84, v85
  v_max3_f32 v169, v169, v86, v87
  v_mfma_f32_32x32x16_bf16 v[72:87], v[36:39], v[16:19], 0
  s_cmp_gt_u32 s73, 5
  s_cbranch_scc1 L_a2_p1done
  v_max3_f32 v155, v155, v56, v57
  v_max3_f32 v169, v169, v58, v59
  v_max3_f32 v155, v155, v60, v61
  v_max3_f32 v169, v169, v62, v63
  v_max3_f32 v155, v155, v64, v65
  v_max3_f32 v169, v169, v66, v67
  v_max3_f32 v155, v155, v68, v69
  v_max3_f32 v169, v169, v70, v71
  v_mfma_f32_32x32x16_bf16 v[56:71], v[32:35], v[16:19], 0
  s_cmp_gt_u32 s73, 4
  s_cbranch_scc1 L_a2_p1done
  v_max3_f32 v155, v155, v72, v73
  v_max3_f32 v169, v169, v74, v75
  v_max3_f32 v155, v155, v76, v77
  v_max3_f32 v169, v169, v78, v79
  v_max3_f32 v155, v155, v80, v81
  v_max3_f32 v169, v169, v82, v83
  v_max3_f32 v155, v155, v84, v85
  v_max3_f32 v169, v169, v86, v87
  v_mfma_f32_32x32x16_bf16 v[72:87], v[28:31], v[16:19], 0
  s_cmp_gt_u32 s73, 3
  s_cbranch_scc1 L_a2_p1done
  v_max3_f32 v155, v155, v56, v57
  v_max3_f32 v169, v169, v58, v59
  v_max3_f32 v155, v155, v60, v61
  v_max3_f32 v169, v169, v62, v63
  v_max3_f32 v155, v155, v64, v65
  v_max3_f32 v169, v169, v66, v67
  v_max3_f32 v155, v155, v68, v69
  v_max3_f32 v169, v169, v70, v71
  v_mfma_f32_32x32x16_bf16 v[56:71], v[24:27], v[16:19], 0
  s_cmp_gt_u32 s73, 2
  s_cbranch_scc1 L_a2_p1done
  v_max3_f32 v155, v155, v72, v73
  v_max3_f32 v169, v169, v74, v75
  v_max3_f32 v155, v155, v76, v77
  v_max3_f32 v169, v169, v78, v79
  v_max3_f32 v155, v155, v80, v81
  v_max3_f32 v169, v169, v82, v83
  v_max3_f32 v155, v155, v84, v85
  v_max3_f32 v169, v169, v86, v87
  s_cmp_gt_u32 s73, 1
  s_cbranch_scc1 L_a2_p1done
  v_max3_f32 v155, v155, v56, v57
  v_max3_f32 v169, v169, v58, v59
  v_max3_f32 v155, v155, v60, v61
  v_max3_f32 v169, v169, v62, v63
  v_max3_f32 v155, v155, v64, v65
  v_max3_f32 v169, v169, v66, v67
  v_max3_f32 v155, v155, v68, v69
  v_max3_f32 v169, v169, v70, v71
L_a2_p1done:
  v_max_f32 v155, v155, v169
  v_mov_b32 v156, v155
  s_nop 1
  v_permlane32_swap_b32 v155, v156
  v_max_f32 v155, v155, v156
  v_sub_f32 v156, 0, v155
  v_mov_b32 v88, v156
  v_mov_b32 v89, v156
  v_mov_b32 v90, v156
  v_mov_b32 v91, v156
  v_mov_b32 v92, v156
  v_mov_b32 v93, v156
  v_mov_b32 v94, v156
  v_mov_b32 v95, v156
  v_mov_b32 v96, v156
  v_mov_b32 v97, v156
  v_mov_b32 v98, v156
  v_mov_b32 v99, v156
  v_mov_b32 v100, v156
  v_mov_b32 v101, v156
  v_mov_b32 v102, v156
  v_mov_b32 v103, v156
  s_nop 1
  v_mfma_f32_32x32x16_bf16 v[56:71], v[48:51], v[16:19], v[88:103]
  v_mfma_f32_32x32x16_bf16 v[72:87], v[44:47], v[16:19], v[88:103]
  ds_read_b128 v[120:123], v193 offset:32896
  ds_read_b128 v[124:127], v194 offset:33408
  ds_read_b128 v[128:131], v193 offset:24576
  ds_read_b128 v[132:135], v194 offset:25088
  s_waitcnt vmcnt(4)
  s_cmp_lt_u32 s61, 4
  s_cbranch_scc1 L_a2_nopub
  s_lshl_b32 s66, s2, 7
  s_lshl_b32 s67, s61, 2
  s_add_u32 s66, s66, s67
  s_add_u32 s66, s66, 65536
  v_mov_b32 v157, s66
  v_mov_b32 v158, s60
  s_mov_b64 s[76:77], exec
  s_mov_b64 exec, 1
  global_store_dword v157, v158, s[38:39] sc1
  s_mov_b64 exec, s[76:77]
L_a2_nopub:
  v_add_f32 v224, v156, v224
  v_add_f32 v225, v156, v225
  v_add_f32 v226, v156, v226
  v_add_f32 v227, v156, v227
  v_add_f32 v228, v156, v228
  v_add_f32 v229, v156, v229
  v_add_f32 v230, v156, v230
  v_add_f32 v231, v156, v231
  v_add_f32 v232, v156, v232
  v_add_f32 v233, v156, v233
  v_add_f32 v234, v156, v234
  v_add_f32 v235, v156, v235
  v_add_f32 v236, v156, v236
  v_add_f32 v237, v156, v237
  v_add_f32 v238, v156, v238
  v_add_f32 v239, v156, v239
  v_exp_f32 v224, v224
  v_exp_f32 v225, v225
  v_exp_f32 v226, v226
  v_exp_f32 v227, v227
  v_exp_f32 v228, v228
  v_exp_f32 v229, v229
  v_exp_f32 v230, v230
  v_exp_f32 v231, v231
  v_exp_f32 v232, v232
  v_exp_f32 v233, v233
  v_exp_f32 v234, v234
  v_exp_f32 v235, v235
  v_exp_f32 v236, v236
  v_exp_f32 v237, v237
  v_exp_f32 v238, v238
  v_exp_f32 v239, v239
  v_cvt_pk_bf16_f32 v104, v224, v225
  v_cvt_pk_bf16_f32 v105, v226, v227
  v_cvt_pk_bf16_f32 v106, v228, v229
  v_cvt_pk_bf16_f32 v107, v230, v231
  v_cvt_pk_bf16_f32 v108, v232, v233
  v_cvt_pk_bf16_f32 v109, v234, v235
  v_cvt_pk_bf16_f32 v110, v236, v237
  v_cvt_pk_bf16_f32 v111, v238, v239
  v_and_b32 v112, v240, v104
  v_and_b32 v113, v241, v105
  v_and_b32 v114, v242, v106
  v_and_b32 v115, v243, v107
  v_and_b32 v116, v244, v108
  v_and_b32 v117, v245, v109
  v_and_b32 v118, v246, v110
  v_and_b32 v119, v247, v111
  v_xor_b32 v104, v112, v104
  v_xor_b32 v105, v113, v105
  v_xor_b32 v106, v114, v106
  v_xor_b32 v107, v115, v107
  v_xor_b32 v108, v116, v108
  v_xor_b32 v109, v117, v109
  v_xor_b32 v110, v118, v110
  v_xor_b32 v111, v119, v111
  s_waitcnt lgkmcnt(0)
  v_mfma_f32_32x32x16_bf16 v[136:151], v[120:123], v[104:107], 0
  s_cmp_gt_u32 s73, 0
  s_cbranch_scc1 L_a2_nopv0
  v_mfma_f32_32x32x16_bf16 v[136:151], v[128:131], v[112:115], v[136:151]
  v_mfma_f32_32x32x16_bf16 v[136:151], v[132:135], v[116:119], v[136:151]
L_a2_nopv0:
  s_cmp_gt_u32 s73, 7
  s_cbranch_scc1 L_st_p2_7
  v_exp_f32 v56, v56
  v_exp_f32 v57, v57
  s_waitcnt lgkmcnt(0)
  v_mfma_f32_32x32x16_bf16 v[136:151], v[124:127], v[108:111], v[136:151]
  v_exp_f32 v58, v58
  v_exp_f32 v59, v59
  v_exp_f32 v60, v60
  v_exp_f32 v61, v61
  v_exp_f32 v62, v62
  v_exp_f32 v63, v63
  v_exp_f32 v64, v64
  v_exp_f32 v65, v65
  ds_read_b128 v[128:131], v193 offset:31856
  ds_read_b128 v[132:135], v194 offset:32368
  v_exp_f32 v66, v66
  v_exp_f32 v67, v67
  s_cmp_ge_u32 s61, 4
  s_cbranch_scc1 L_a2_nowo7
  s_add_u32 m0, s7, 81920
  s_add_u32 s67, s6, 0
  buffer_load_dwordx4 v202, s[56:59], s67 offen  lds
  s_add_u32 m0, s7, 82944
  s_add_u32 s67, s6, 8192
  buffer_load_dwordx4 v202, s[56:59], s67 offen  lds
  s_add_u32 m0, s7, 83968
  s_add_u32 s67, s6, 16384
  buffer_load_dwordx4 v202, s[56:59], s67 offen  lds
  s_add_u32 m0, s7, 84992
  s_add_u32 s67, s6, 24576
  buffer_load_dwordx4 v202, s[56:59], s67 offen  lds
L_a2_nowo7:
  v_exp_f32 v68, v68
  v_exp_f32 v69, v69
  v_exp_f32 v70, v70
  v_exp_f32 v71, v71
  v_cvt_pk_bf16_f32 v112, v56, v57
  v_cvt_pk_bf16_f32 v113, v58, v59
  v_cvt_pk_bf16_f32 v114, v60, v61
  v_cvt_pk_bf16_f32 v115, v62, v63
  v_cvt_pk_bf16_f32 v116, v64, v65
  v_cvt_pk_bf16_f32 v117, v66, v67
  v_cvt_pk_bf16_f32 v118, v68, v69
  v_cvt_pk_bf16_f32 v119, v70, v71
  v_mfma_f32_32x32x16_bf16 v[56:71], v[40:43], v[16:19], v[88:103]
  s_cmp_gt_u32 s73, 6
  s_cbranch_scc1 L_st_p2_6
  v_exp_f32 v72, v72
  v_exp_f32 v73, v73
  s_waitcnt lgkmcnt(0)
  v_mfma_f32_32x32x16_bf16 v[136:151], v[128:131], v[112:115], v[136:151]
  v_exp_f32 v74, v74
  v_exp_f32 v75, v75
  v_exp_f32 v76, v76
  v_exp_f32 v77, v77
  v_exp_f32 v78, v78
  v_exp_f32 v79, v79
  v_mfma_f32_32x32x16_bf16 v[136:151], v[132:135], v[116:119], v[136:151]
  v_exp_f32 v80, v80
  v_exp_f32 v81, v81
  ds_read_b128 v[120:123], v193 offset:30816
  ds_read_b128 v[124:127], v194 offset:31328
  v_exp_f32 v82, v82
  v_exp_f32 v83, v83
  s_cmp_ge_u32 s61, 4
  s_cbranch_scc1 L_a2_nowo6
  s_add_u32 m0, s7, 86016
  s_add_u32 s67, s6, 32768
  buffer_load_dwordx4 v202, s[56:59], s67 offen  lds
  s_add_u32 m0, s7, 87040
  s_add_u32 s67, s6, 40960
  buffer_load_dwordx4 v202, s[56:59], s67 offen  lds
  s_add_u32 m0, s7, 88064
  s_add_u32 s67, s6, 49152
  buffer_load_dwordx4 v202, s[56:59], s67 offen  lds
  s_add_u32 m0, s7, 89088
  s_add_u32 s67, s6, 57344
  buffer_load_dwordx4 v202, s[56:59], s67 offen  lds
L_a2_nowo6:
  v_exp_f32 v84, v84
  v_exp_f32 v85, v85
  v_exp_f32 v86, v86
  v_exp_f32 v87, v87
  v_cvt_pk_bf16_f32 v104, v72, v73
  v_cvt_pk_bf16_f32 v105, v74, v75
  v_cvt_pk_bf16_f32 v106, v76, v77
  v_cvt_pk_bf16_f32 v107, v78, v79
  v_cvt_pk_bf16_f32 v108, v80, v81
  v_cvt_pk_bf16_f32 v109, v82, v83
  v_cvt_pk_bf16_f32 v110, v84, v85
  v_cvt_pk_bf16_f32 v111, v86, v87
  v_mfma_f32_32x32x16_bf16 v[72:87], v[36:39], v[16:19], v[88:103]
  s_cmp_gt_u32 s73, 5
  s_cbranch_scc1 L_st_p2_5
  v_exp_f32 v56, v56
  v_exp_f32 v57, v57
  s_waitcnt lgkmcnt(0)
  v_mfma_f32_32x32x16_bf16 v[136:151], v[120:123], v[104:107], v[136:151]
  v_exp_f32 v58, v58
  v_exp_f32 v59, v59
  v_exp_f32 v60, v60
  v_exp_f32 v61, v61
  v_exp_f32 v62, v62
  v_exp_f32 v63, v63
  v_mfma_f32_32x32x16_bf16 v[136:151], v[124:127], v[108:111], v[136:151]
  v_exp_f32 v64, v64
  v_exp_f32 v65, v65
  ds_read_b128 v[128:131], v193 offset:29776
  ds_read_b128 v[132:135], v194 offset:30288
  v_exp_f32 v66, v66
  v_exp_f32 v67, v67
  s_cmp_ge_u32 s61, 4
  s_cbranch_scc1 L_a2_nowo5
  s_add_u32 m0, s7, 114688
  s_add_u32 s67, s6, 262144
  buffer_load_dwordx4 v202, s[56:59], s67 offen  lds
  s_add_u32 m0, s7, 115712
  s_add_u32 s67, s6, 270336
  buffer_load_dwordx4 v202, s[56:59], s67 offen  lds
  s_add_u32 m0, s7, 116736
  s_add_u32 s67, s6, 278528
  buffer_load_dwordx4 v202, s[56:59], s67 offen  lds
  s_add_u32 m0, s7, 117760
  s_add_u32 s67, s6, 286720
  buffer_load_dwordx4 v202, s[56:59], s67 offen  lds
L_a2_nowo5:
  v_exp_f32 v68, v68
  v_exp_f32 v69, v69
  v_exp_f32 v70, v70
  v_exp_f32 v71, v71
  v_cvt_pk_bf16_f32 v112, v56, v57
  v_cvt_pk_bf16_f32 v113, v58, v59
  v_cvt_pk_bf16_f32 v114, v60, v61
  v_cvt_pk_bf16_f32 v115, v62, v63
  v_cvt_pk_bf16_f32 v116, v64, v65
  v_cvt_pk_bf16_f32 v117, v66, v67
  v_cvt_pk_bf16_f32 v118, v68, v69
  v_cvt_pk_bf16_f32 v119, v70, v71
  v_mfma_f32_32x32x16_bf16 v[56:71], v[32:35], v[16:19], v[88:103]
  s_cmp_gt_u32 s73, 4
  s_cbranch_scc1 L_st_p2_4
  v_exp_f32 v72, v72
  v_exp_f32 v73, v73
  s_waitcnt lgkmcnt(0)
  v_mfma_f32_32x32x16_bf16 v[136:151], v[128:131], v[112:115], v[136:151]
  v_exp_f32 v74, v74
  v_exp_f32 v75, v75
  v_exp_f32 v76, v76
  v_exp_f32 v77, v77
  v_exp_f32 v78, v78
  v_exp_f32 v79, v79
  v_mfma_f32_32x32x16_bf16 v[136:151], v[132:135], v[116:119], v[136:151]
  v_exp_f32 v80, v80
  v_exp_f32 v81, v81
  ds_read_b128 v[120:123], v193 offset:28736
  ds_read_b128 v[124:127], v194 offset:29248
  v_exp_f32 v82, v82
  v_exp_f32 v83, v83
  s_cmp_ge_u32 s61, 4
  s_cbranch_scc1 L_a2_nowo4
  s_add_u32 m0, s7, 118784
  s_add_u32 s67, s6, 294912
  buffer_load_dwordx4 v202, s[56:59], s67 offen  lds
  s_add_u32 m0, s7, 119808
  s_add_u32 s67, s6, 303104
  buffer_load_dwordx4 v202, s[56:59], s67 offen  lds
  s_add_u32 m0, s7, 120832
  s_add_u32 s67, s6, 311296
  buffer_load_dwordx4 v202, s[56:59], s67 offen  lds
  s_add_u32 m0, s7, 121856
  s_add_u32 s67, s6, 319488
  buffer_load_dwordx4 v202, s[56:59], s67 offen  lds
L_a2_nowo4:
  v_exp_f32 v84, v84
  v_exp_f32 v85, v85
  v_exp_f32 v86, v86
  v_exp_f32 v87, v87
  v_cvt_pk_bf16_f32 v104, v72, v73
  v_cvt_pk_bf16_f32 v105, v74, v75
  v_cvt_pk_bf16_f32 v106, v76, v77
  v_cvt_pk_bf16_f32 v107, v78, v79
  v_cvt_pk_bf16_f32 v108, v80, v81
  v_cvt_pk_bf16_f32 v109, v82, v83
  v_cvt_pk_bf16_f32 v110, v84, v85
  v_cvt_pk_bf16_f32 v111, v86, v87
  v_mfma_f32_32x32x16_bf16 v[72:87], v[28:31], v[16:19], v[88:103]
  s_cmp_gt_u32 s73, 3
  s_cbranch_scc1 L_st_p2_3
  v_exp_f32 v56, v56
  v_exp_f32 v57, v57
  s_waitcnt lgkmcnt(0)
  v_mfma_f32_32x32x16_bf16 v[136:151], v[120:123], v[104:107], v[136:151]
  v_exp_f32 v58, v58
  v_exp_f32 v59, v59
  v_exp_f32 v60, v60
  v_exp_f32 v61, v61
  v_exp_f32 v62, v62
  v_exp_f32 v63, v63
  v_mfma_f32_32x32x16_bf16 v[136:151], v[124:127], v[108:111], v[136:151]
  v_exp_f32 v64, v64
  v_exp_f32 v65, v65
  ds_read_b128 v[128:131], v193 offset:27696
  ds_read_b128 v[132:135], v194 offset:28208
  v_exp_f32 v66, v66
  v_exp_f32 v67, v67
  v_exp_f32 v68, v68
  v_exp_f32 v69, v69
  s_cmp_lg_u32 s61, 0
  s_cbranch_scc1 L_a2_nosample
  global_load_dword v165, v196, s[38:39] sc1
L_a2_nosample:
  v_exp_f32 v70, v70
  v_exp_f32 v71, v71
  v_cvt_pk_bf16_f32 v112, v56, v57
  v_cvt_pk_bf16_f32 v113, v58, v59
  v_cvt_pk_bf16_f32 v114, v60, v61
  v_cvt_pk_bf16_f32 v115, v62, v63
  v_cvt_pk_bf16_f32 v116, v64, v65
  v_cvt_pk_bf16_f32 v117, v66, v67
  v_cvt_pk_bf16_f32 v118, v68, v69
  v_cvt_pk_bf16_f32 v119, v70, v71
  v_mfma_f32_32x32x16_bf16 v[56:71], v[24:27], v[16:19], v[88:103]
  s_cmp_gt_u32 s73, 2
  s_cbranch_scc1 L_st_p2_2
  v_exp_f32 v72, v72
  v_exp_f32 v73, v73
  s_waitcnt lgkmcnt(0)
  v_mfma_f32_32x32x16_bf16 v[136:151], v[128:131], v[112:115], v[136:151]
  v_exp_f32 v74, v74
  v_exp_f32 v75, v75
  v_exp_f32 v76, v76
  v_exp_f32 v77, v77
  v_exp_f32 v78, v78
  v_exp_f32 v79, v79
  v_mfma_f32_32x32x16_bf16 v[136:151], v[132:135], v[116:119], v[136:151]
  v_exp_f32 v80, v80
  v_exp_f32 v81, v81
  ds_read_b128 v[120:123], v193 offset:26656
  ds_read_b128 v[124:127], v194 offset:27168
  v_exp_f32 v82, v82
  v_exp_f32 v83, v83
  v_exp_f32 v84, v84
  v_exp_f32 v85, v85
  v_exp_f32 v86, v86
  v_exp_f32 v87, v87
  v_cvt_pk_bf16_f32 v104, v72, v73
  v_cvt_pk_bf16_f32 v105, v74, v75
  v_cvt_pk_bf16_f32 v106, v76, v77
  v_cvt_pk_bf16_f32 v107, v78, v79
  v_cvt_pk_bf16_f32 v108, v80, v81
  v_cvt_pk_bf16_f32 v109, v82, v83
  v_cvt_pk_bf16_f32 v110, v84, v85
  v_cvt_pk_bf16_f32 v111, v86, v87
  s_cmp_gt_u32 s73, 1
  s_cbranch_scc1 L_st_p2_1
  v_exp_f32 v56, v56
  v_exp_f32 v57, v57
  s_waitcnt lgkmcnt(0)
  v_mfma_f32_32x32x16_bf16 v[136:151], v[120:123], v[104:107], v[136:151]
  v_exp_f32 v58, v58
  v_exp_f32 v59, v59
  v_exp_f32 v60, v60
  v_exp_f32 v61, v61
  v_exp_f32 v62, v62
  v_exp_f32 v63, v63
  v_mfma_f32_32x32x16_bf16 v[136:151], v[124:127], v[108:111], v[136:151]
  v_exp_f32 v64, v64
  v_exp_f32 v65, v65
  ds_read_b128 v[128:131], v193 offset:25616
  ds_read_b128 v[132:135], v194 offset:26128
  v_exp_f32 v66, v66
  v_exp_f32 v67, v67
  v_exp_f32 v68, v68
  v_exp_f32 v69, v69
  v_exp_f32 v70, v70
  v_exp_f32 v71, v71
  v_cvt_pk_bf16_f32 v112, v56, v57
  v_cvt_pk_bf16_f32 v113, v58, v59
  v_cvt_pk_bf16_f32 v114, v60, v61
  v_cvt_pk_bf16_f32 v115, v62, v63
  v_cvt_pk_bf16_f32 v116, v64, v65
  v_cvt_pk_bf16_f32 v117, v66, v67
  v_cvt_pk_bf16_f32 v118, v68, v69
  v_cvt_pk_bf16_f32 v119, v70, v71
  s_waitcnt lgkmcnt(0)
  v_mfma_f32_32x32x16_bf16 v[136:151], v[128:131], v[112:115], v[136:151]
  v_mfma_f32_32x32x16_bf16 v[136:151], v[132:135], v[116:119], v[136:151]
L_a2_p2done:
  s_nop 15
  v_rcp_f32 v155, v144
  s_nop 0
  v_mul_f32 v136, v155, v136
  v_mul_f32 v137, v155, v137
  v_mul_f32 v138, v155, v138
  v_mul_f32 v139, v155, v139
  v_mul_f32 v140, v155, v140
  v_mul_f32 v141, v155, v141
  v_mul_f32 v142, v155, v142
  v_mul_f32 v143, v155, v143
  v_cvt_pk_bf16_f32 v104, v136, v137
  v_cvt_pk_bf16_f32 v105, v138, v139
  v_cvt_pk_bf16_f32 v106, v140, v141
  v_cvt_pk_bf16_f32 v107, v142, v143
  global_store_dwordx4 v201, v[104:107], s[38:39] sc1
  v_and_b32 v248, 31, v1
  v_lshrrev_b32 v249, 5, v1
  s_lshl_b32 s66, s61, 1
  v_add_u32 v249, s66, v249
  v_lshrrev_b32 v250, 1, v249
  v_and_b32 v251, 7, v248
  v_xor_b32 v250, v250, v251
  v_lshlrev_b32 v250, 4, v250
  v_and_b32 v251, 1, v249
  v_lshl_add_u32 v250, v251, 3, v250
  v_lshl_add_u32 v250, v248, 8, v250
  v_add_u32 v200, 65536, v250
  s_lshr_b32 s97, s64, 2
  s_lshl_b32 s97, s97, 1
  s_and_b32 s66, s63, 1
  s_add_u32 s97, s97, s66
  s_lshl_b32 s97, s97, 2
  s_and_b32 s66, s62, 3
  s_add_u32 s97, s97, s66
  s_and_b32 s68, s61, 1
  s_lshl_b32 s66, s97, 1
  s_add_u32 s68, s68, s66
  v_mov_b32 v248, s68
  s_lshr_b32 s66, s61, 1
  s_lshl_b32 s66, s66, 3
  v_and_b32 v249, 7, v1
  v_add_u32 v249, s66, v249
  s_lshl_b32 s6, s68, 5
  s_add_u32 s6, s6, s66
  s_lshl_b32 s6, s6, 10
  s_add_u32 s6, s6, 5242880
  v_lshrrev_b32 v250, 2, v248
  v_lshrrev_b32 v251, 1, v249
  v_and_b32 v252, 3, v250
  v_and_b32 v253, 7, v251
  v_lshl_add_u32 v252, v253, 2, v252
  v_lshlrev_b32 v252, 3, v252
  v_lshrrev_b32 v253, 2, v250
  v_lshrrev_b32 v250, 1, v253
  v_xor_b32 v253, v253, v250
  v_lshl_add_u32 v252, v253, 1, v252
  v_lshrrev_b32 v253, 3, v251
  v_add_u32 v252, v252, v253
  v_and_b32 v253, 3, v248
  v_and_b32 v250, 1, v249
  v_lshl_add_u32 v253, v250, 2, v253
  v_lshl_add_u32 v252, v252, 3, v253
  v_lshlrev_b32 v252, 7, v252
  v_add_u32 v197, 524288, v252
  v_lshrrev_b32 v248, 3, v1
  v_and_b32 v249, 7, v1
  v_lshrrev_b32 v250, 1, v248
  v_xor_b32 v249, v249, v250
  v_lshlrev_b32 v248, 12, v248
  v_lshl_add_u32 v198, v249, 4, v248
  v_xor_b32 v249, 4, v249
  v_lshl_add_u32 v199, v249, 4, v248
  v_and_b32 v248, 15, v1
  v_lshrrev_b32 v248, 2, v248
  v_lshrrev_b32 v249, 5, v1
  v_lshl_add_u32 v249, v249, 2, v248
  v_lshlrev_b32 v249, 7, v249
  v_lshrrev_b32 v248, 1, v248
  v_lshl_add_u32 v249, v248, 6, v249
  v_bfe_u32 v248, v1, 4, 1
  v_lshl_add_u32 v249, v248, 5, v249
  v_and_b32 v248, 3, v1
  v_lshl_add_u32 v249, v248, 3, v249
  s_lshr_b32 s67, s61, 1
  s_lshl_b32 s68, s67, 14
  s_add_u32 s66, s68, 81920
  v_add_u32 v204, s66, v249
  v_xor_b32 v203, 64, v204
  v_and_b32 v248, 31, v1
  v_lshrrev_b32 v249, 5, v1
  v_and_b32 v250, 15, v248
  v_xor_b32 v249, v249, v250
  v_lshlrev_b32 v249, 4, v249
  s_and_b32 s66, s61, 1
  s_lshl_b32 s66, s66, 13
  s_add_u32 s66, s66, s68
  s_add_u32 s66, s66, 0
  v_lshl_add_u32 v249, v248, 8, v249
  v_add_u32 v249, s66, v249
  v_xor_b32 v9, 0, v249
  v_xor_b32 v10, 32, v249
  v_xor_b32 v11, 64, v249
  v_xor_b32 v12, 96, v249
  v_lshrrev_b32 v248, 3, v0
  v_and_b32 v249, 7, v0
  v_lshlrev_b32 v250, 1, v249
  v_and_b32 v251, 15, v248
  v_xor_b32 v250, v250, v251
  v_lshlrev_b32 v250, 4, v250
  v_lshl_add_u32 v250, v248, 8, v250
  v_add_u32 v13, 0, v250
  v_xor_b32 v14, 16, v13
  s_lshl_b32 s66, s97, 17
  s_lshr_b32 s67, s62, 2
  s_lshl_b32 s67, s67, 7
  s_add_u32 s66, s66, s67
  v_lshlrev_b32 v250, 11, v248
  v_lshl_add_u32 v250, v249, 4, v250
  v_add_u32 v205, s66, v250
  s_waitcnt vmcnt(0)
  s_lshl_b32 s66, s2, 3
  s_add_u32 s66, s66, s61
  s_lshl_b32 s66, s66, 7
  s_add_u32 s66, s66, 524288
  v_mov_b32 v157, s66
  v_mov_b32 v158, s60
  s_mov_b64 s[76:77], exec
  s_mov_b64 exec, 1
  global_store_dword v157, v158, s[38:39] sc1
  s_mov_b64 exec, s[76:77]
  s_cmp_lg_u32 s61, 0
  s_cbranch_scc1 L_nob2poll
  v_cmp_ne_u32 vcc, s60, v165
  s_cbranch_vccz L_poll_b2_done
  s_mov_b32 s74, 200000
L_poll_b2:
  global_load_dword v165, v196, s[38:39] sc1
  s_waitcnt vmcnt(0)
  v_cmp_ne_u32 vcc, s60, v165
  s_cbranch_vccz L_poll_b2_done
  s_sub_u32 s74, s74, 1
  s_cmp_lg_u32 s74, 0
  s_cbranch_scc1 L_poll_b2
L_poll_b2_done:
  s_lshl_b32 s66, s63, 18
  s_lshl_b32 s67, s62, 7
  s_add_u32 s66, s66, s67
  s_add_u32 s66, s66, 9437184
  s_mov_b32 m0, 65536
  s_add_u32 s67, s66, 0
  buffer_load_dwordx4 v198, s[52:55], s67 offen sc1 lds
  s_mov_b32 m0, 66560
  s_add_u32 s67, s66, 32768
  buffer_load_dwordx4 v199, s[52:55], s67 offen sc1 lds
  s_mov_b32 m0, 67584
  s_add_u32 s67, s66, 65536
  buffer_load_dwordx4 v198, s[52:55], s67 offen sc1 lds
  s_mov_b32 m0, 68608
  s_add_u32 s67, s66, 98304
  buffer_load_dwordx4 v199, s[52:55], s67 offen sc1 lds
  s_mov_b32 m0, 69632
  s_add_u32 s67, s66, 131072
  buffer_load_dwordx4 v198, s[52:55], s67 offen sc1 lds
  s_mov_b32 m0, 70656
  s_add_u32 s67, s66, 163840
  buffer_load_dwordx4 v199, s[52:55], s67 offen sc1 lds
  s_mov_b32 m0, 71680
  s_add_u32 s67, s66, 196608
  buffer_load_dwordx4 v198, s[52:55], s67 offen sc1 lds
  s_mov_b32 m0, 72704
  s_add_u32 s67, s66, 229376
  buffer_load_dwordx4 v199, s[52:55], s67 offen sc1 lds
L_nob2poll:
L_noep:
  s_barrier
  ds_read_b64_tr_b16 v[32:33], v204 offset:0
  ds_read_b64_tr_b16 v[34:35], v204 offset:1024
  ds_read_b64_tr_b16 v[36:37], v203 offset:0
  ds_read_b64_tr_b16 v[38:39], v203 offset:1024
  ds_read_b64_tr_b16 v[40:41], v204 offset:2048
  ds_read_b64_tr_b16 v[42:43], v204 offset:3072
  ds_read_b64_tr_b16 v[44:45], v203 offset:2048
  ds_read_b64_tr_b16 v[46:47], v203 offset:3072
  ds_read_b64_tr_b16 v[48:49], v204 offset:4096
  ds_read_b64_tr_b16 v[50:51], v204 offset:5120
  ds_read_b64_tr_b16 v[52:53], v203 offset:4096
  ds_read_b64_tr_b16 v[54:55], v203 offset:5120
  ds_read_b64_tr_b16 v[56:57], v204 offset:6144
  ds_read_b64_tr_b16 v[58:59], v204 offset:7168
  ds_read_b64_tr_b16 v[60:61], v203 offset:6144
  ds_read_b64_tr_b16 v[62:63], v203 offset:7168
  ds_read_b64_tr_b16 v[64:65], v204 offset:8192
  ds_read_b64_tr_b16 v[66:67], v204 offset:9216
  ds_read_b64_tr_b16 v[68:69], v203 offset:8192
  ds_read_b64_tr_b16 v[70:71], v203 offset:9216
  ds_read_b64_tr_b16 v[72:73], v204 offset:10240
  ds_read_b64_tr_b16 v[74:75], v204 offset:11264
  ds_read_b64_tr_b16 v[76:77], v203 offset:10240
  ds_read_b64_tr_b16 v[78:79], v203 offset:11264
  ds_read_b64_tr_b16 v[80:81], v204 offset:12288
  ds_read_b64_tr_b16 v[82:83], v204 offset:13312
  ds_read_b64_tr_b16 v[84:85], v203 offset:12288
  ds_read_b64_tr_b16 v[86:87], v203 offset:13312
  ds_read_b64_tr_b16 v[88:89], v204 offset:14336
  ds_read_b64_tr_b16 v[90:91], v204 offset:15360
  ds_read_b64_tr_b16 v[92:93], v203 offset:14336
  ds_read_b64_tr_b16 v[94:95], v203 offset:15360
  v_mov_b32 v20, 163824
  s_cmp_lg_u32 s61, 0
  s_cbranch_scc1 L_nosig
  s_waitcnt vmcnt(0)
  v_mov_b32 v21, s60
  ds_write_b32 v20, v21
L_nosig:
  s_mov_b32 s74, 1600000
L_y_spin:
  ds_read_b32 v21, v20
  s_waitcnt lgkmcnt(0)
  v_cmp_ne_u32 vcc, s60, v21
  s_cbranch_vccz L_y_ok
  s_sub_u32 s74, s74, 1
  s_cmp_lg_u32 s74, 0
  s_cbranch_scc1 L_y_spin
L_y_ok:
  ds_read_b64 v[22:23], v200
  ds_read_b64 v[24:25], v200 offset:128
  v_lshlrev_b32 v136, 16, v160
  v_and_b32 v137, 0xffff0000, v160
  v_lshlrev_b32 v138, 16, v161
  v_and_b32 v139, 0xffff0000, v161
  v_lshlrev_b32 v140, 16, v162
  v_and_b32 v141, 0xffff0000, v162
  v_lshlrev_b32 v142, 16, v163
  v_and_b32 v143, 0xffff0000, v163
  s_waitcnt lgkmcnt(0)
  v_lshlrev_b32 v144, 16, v22
  v_lshlrev_b32 v145, 16, v24
  v_and_b32 v146, 0xffff0000, v22
  v_and_b32 v147, 0xffff0000, v24
  v_lshlrev_b32 v148, 16, v23
  v_lshlrev_b32 v149, 16, v25
  v_and_b32 v150, 0xffff0000, v23
  v_and_b32 v151, 0xffff0000, v25
  v_pk_mul_f32 v[144:145], v[144:145], v[136:137]
  v_pk_mul_f32 v[146:147], v[146:147], v[138:139]
  v_pk_mul_f32 v[148:149], v[148:149], v[140:141]
  v_pk_mul_f32 v[150:151], v[150:151], v[142:143]
  v_cvt_pk_bf16_f32 v152, v144, v145
  v_cvt_pk_bf16_f32 v153, v146, v147
  v_cvt_pk_bf16_f32 v154, v148, v149
  v_cvt_pk_bf16_f32 v155, v150, v151
  v_add_u32 v21, 0x1000, v8
  global_store_dword v8, v152, s[34:35] nt
  global_store_dword v8, v153, s[34:35] offset:2048 nt
  global_store_dword v21, v154, s[34:35] nt
  global_store_dword v21, v155, s[34:35] offset:2048 nt
  v_xor_b32 v248, 128, v9
  v_xor_b32 v249, 128, v10
  v_xor_b32 v250, 128, v11
  v_xor_b32 v251, 128, v12
  s_mov_b32 s74, 200000
L_poll_a2:
  global_load_dword v31, v197, s[38:39] sc1
  s_waitcnt vmcnt(0)
  v_cmp_ne_u32 vcc, s60, v31
  s_cbranch_vccz L_poll_a2_done
  s_sub_u32 s74, s74, 1
  s_cmp_lg_u32 s74, 0
  s_cbranch_scc1 L_poll_a2
L_poll_a2_done:
  s_add_u32 s68, s6, 0
  buffer_load_dwordx4 v[96:99], v206, s[52:55], s68 offen sc1
  s_add_u32 s68, s6, 1024
  buffer_load_dwordx4 v[100:103], v206, s[52:55], s68 offen sc1
  s_add_u32 s68, s6, 2048
  buffer_load_dwordx4 v[104:107], v206, s[52:55], s68 offen sc1
  s_add_u32 s68, s6, 3072
  buffer_load_dwordx4 v[108:111], v206, s[52:55], s68 offen sc1
  s_add_u32 s68, s6, 4096
  buffer_load_dwordx4 v[112:115], v206, s[52:55], s68 offen sc1
  s_add_u32 s68, s6, 5120
  buffer_load_dwordx4 v[116:119], v206, s[52:55], s68 offen sc1
  s_add_u32 s68, s6, 6144
  buffer_load_dwordx4 v[120:123], v206, s[52:55], s68 offen sc1
  s_add_u32 s68, s6, 7168
  buffer_load_dwordx4 v[124:127], v206, s[52:55], s68 offen sc1
  s_waitcnt vmcnt(7)
  v_mfma_f32_32x32x16_bf16 v[128:143], v[32:35], v[96:99], 0
  v_mfma_f32_32x32x16_bf16 v[144:159], v[36:39], v[96:99], 0
  s_waitcnt vmcnt(6)
  v_mfma_f32_32x32x16_bf16 v[128:143], v[40:43], v[100:103], v[128:143]
  v_mfma_f32_32x32x16_bf16 v[144:159], v[44:47], v[100:103], v[144:159]
  s_waitcnt vmcnt(5)
  v_mfma_f32_32x32x16_bf16 v[128:143], v[48:51], v[104:107], v[128:143]
  v_mfma_f32_32x32x16_bf16 v[144:159], v[52:55], v[104:107], v[144:159]
  s_waitcnt vmcnt(4)
  v_mfma_f32_32x32x16_bf16 v[128:143], v[56:59], v[108:111], v[128:143]
  v_mfma_f32_32x32x16_bf16 v[144:159], v[60:63], v[108:111], v[144:159]
  s_waitcnt vmcnt(3)
  v_mfma_f32_32x32x16_bf16 v[128:143], v[64:67], v[112:115], v[128:143]
  v_mfma_f32_32x32x16_bf16 v[144:159], v[68:71], v[112:115], v[144:159]
  s_waitcnt vmcnt(2)
  v_mfma_f32_32x32x16_bf16 v[128:143], v[72:75], v[116:119], v[128:143]
  v_mfma_f32_32x32x16_bf16 v[144:159], v[76:79], v[116:119], v[144:159]
  s_waitcnt vmcnt(1)
  v_mfma_f32_32x32x16_bf16 v[128:143], v[80:83], v[120:123], v[128:143]
  v_mfma_f32_32x32x16_bf16 v[144:159], v[84:87], v[120:123], v[144:159]
  s_waitcnt vmcnt(0)
  v_mfma_f32_32x32x16_bf16 v[128:143], v[88:91], v[124:127], v[128:143]
  v_mfma_f32_32x32x16_bf16 v[144:159], v[92:95], v[124:127], v[144:159]
  s_nop 10
  ds_write_b128 v9, v[128:131]
  ds_write_b128 v10, v[132:135]
  ds_write_b128 v11, v[136:139]
  ds_write_b128 v12, v[140:143]
  ds_write_b128 v248, v[144:147]
  ds_write_b128 v249, v[148:151]
  ds_write_b128 v250, v[152:155]
  ds_write_b128 v251, v[156:159]
  s_waitcnt lgkmcnt(0)
  s_barrier
  ds_read_b128 v[32:35], v13 offset:0
  ds_read_b128 v[36:39], v14 offset:0
  ds_read_b128 v[40:43], v13 offset:16384
  ds_read_b128 v[44:47], v14 offset:16384
  ds_read_b128 v[48:51], v13 offset:32768
  ds_read_b128 v[52:55], v14 offset:32768
  ds_read_b128 v[56:59], v13 offset:49152
  ds_read_b128 v[60:63], v14 offset:49152
  s_waitcnt lgkmcnt(4)
  v_add_f32 v32, v32, v40
  v_add_f32 v33, v33, v41
  v_add_f32 v34, v34, v42
  v_add_f32 v35, v35, v43
  v_add_f32 v36, v36, v44
  v_add_f32 v37, v37, v45
  v_add_f32 v38, v38, v46
  v_add_f32 v39, v39, v47
  s_waitcnt lgkmcnt(0)
  v_add_f32 v48, v48, v56
  v_add_f32 v49, v49, v57
  v_add_f32 v50, v50, v58
  v_add_f32 v51, v51, v59
  v_add_f32 v52, v52, v60
  v_add_f32 v53, v53, v61
  v_add_f32 v54, v54, v62
  v_add_f32 v55, v55, v63
  v_add_f32 v32, v32, v48
  v_add_f32 v33, v33, v49
  v_add_f32 v34, v34, v50
  v_add_f32 v35, v35, v51
  v_add_f32 v36, v36, v52
  v_add_f32 v37, v37, v53
  v_add_f32 v38, v38, v54
  v_add_f32 v39, v39, v55
  v_cvt_pk_bf16_f32 v64, v32, v33
  v_cvt_pk_bf16_f32 v65, v34, v35
  v_cvt_pk_bf16_f32 v66, v36, v37
  v_cvt_pk_bf16_f32 v67, v38, v39
  global_store_dwordx4 v205, v[64:67], s[34:35] nt
L_end:
  s_endpgm
L_sub_b:
  s_lshr_b32 s96, s61, 2
  s_lshl_b32 s66, s64, 2
  s_add_u32 s66, s66, s72
  s_sub_i32 s73, 8, s66
  s_max_i32 s73, s73, 0
  v_lshlrev_b32 v206, 4, v1
  s_lshl_b32 s66, s96, 12
  s_lshl_b32 s67, s72, 10
  s_add_u32 s66, s66, s67
  v_add_u32 v195, s66, v206
  s_mul_i32 s66, s96, 12288
  s_add_u32 s66, s66, s67
  v_add_u32 v192, s66, v206
  s_mul_i32 s66, s96, 12480
  s_mul_i32 s67, s72, 1040
  s_add_u32 s66, s66, s67
  v_and_b32 v248, 15, v1
  v_lshlrev_b32 v248, 4, v248
  v_lshrrev_b32 v249, 5, v1
  v_lshl_add_u32 v248, v249, 8, v248
  v_bfe_u32 v249, v1, 4, 1
  v_cmp_eq_u32 vcc, 1, v249
  v_mov_b32 v249, 1024
  v_mov_b32 v250, 512
  v_cndmask_b32 v193, v248, v249, vcc
  v_cndmask_b32 v194, v248, v250, vcc
  v_add_u32 v193, s66, v193
  v_add_u32 v194, s66, v194
  s_lshl_b32 s66, s64, 2
  s_add_u32 s66, s66, s72
  s_lshl_b32 s66, s66, 5
  s_lshl_b32 s67, s65, 1
  s_add_u32 s66, s66, s67
  s_add_u32 s66, s66, s96
  s_lshl_b32 s66, s66, 10
  s_add_u32 s66, s66, 5242880
  v_add_u32 v201, s66, v206
  v_and_b32 v248, 31, v1
  v_lshrrev_b32 v249, 5, v1
  s_lshl_b32 s66, s61, 1
  v_add_u32 v249, s66, v249
  s_lshl_b32 s66, s62, 6
  v_lshlrev_b32 v250, 2, v249
  v_add_u32 v250, s66, v250
  s_lshl_b32 s66, s63, 7
  v_lshlrev_b32 v251, 2, v248
  v_add_u32 v251, s66, v251
  v_lshl_add_u32 v207, v250, 10, v251
  v_lshl_add_u32 v8, v250, 11, v251
  v_add_u32 v8, 1024, v8
  s_setpc_b64 s[4:5]
L_st_epoch:
  s_mov_b32 s74, 200000
  v_lshlrev_b32 v20, 7, v1
  v_add_u32 v20, 0, v20
  v_add_u32 v21, 8192, v20
  v_add_u32 v22, 16384, v20
  v_add_u32 v23, 24576, v20
L_ep_spin:
  global_load_dword v24, v20, s[38:39] sc1
  global_load_dword v25, v21, s[38:39] sc1
  global_load_dword v26, v22, s[38:39] sc1
  global_load_dword v27, v23, s[38:39] sc1
  s_waitcnt vmcnt(0)
  v_cmp_ne_u32 vcc, s60, v24
  v_cmp_ne_u32 s[82:83], s60, v25
  v_cmp_ne_u32 s[84:85], s60, v26
  v_cmp_ne_u32 s[86:87], s60, v27
  s_nop 1
  s_or_b64 vcc, vcc, s[82:83]
  s_or_b64 vcc, vcc, s[84:85]
  s_or_b64 vcc, vcc, s[86:87]
  s_cbranch_vccz L_ep_ok
  s_sub_u32 s74, s74, 1
  s_cmp_lg_u32 s74, 0
  s_cbranch_scc1 L_ep_spin
L_ep_ok:
  v_mov_b32 v20, 131072
  v_mov_b32 v21, s60
  s_mov_b64 s[76:77], exec
  s_mov_b64 exec, 1
  global_store_dword v20, v21, s[38:39] sc1
  s_mov_b64 exec, s[76:77]
  s_branch L_epdone
L_st_nomerge:
  s_nop 15
  s_branch L_a2_nomerge
L_st_p2_7:
  s_waitcnt lgkmcnt(0)
  s_nop 1
  v_mfma_f32_32x32x16_bf16 v[136:151], v[124:127], v[108:111], v[136:151]
  s_cmp_ge_u32 s61, 4
  s_cbranch_scc1 L_st_nowo7
  s_add_u32 m0, s7, 81920
  s_add_u32 s67, s6, 0
  buffer_load_dwordx4 v202, s[56:59], s67 offen  lds
  s_add_u32 m0, s7, 82944
  s_add_u32 s67, s6, 8192
  buffer_load_dwordx4 v202, s[56:59], s67 offen  lds
  s_add_u32 m0, s7, 83968
  s_add_u32 s67, s6, 16384
  buffer_load_dwordx4 v202, s[56:59], s67 offen  lds
  s_add_u32 m0, s7, 84992
  s_add_u32 s67, s6, 24576
  buffer_load_dwordx4 v202, s[56:59], s67 offen  lds
  s_add_u32 m0, s7, 86016
  s_add_u32 s67, s6, 32768
  buffer_load_dwordx4 v202, s[56:59], s67 offen  lds
  s_add_u32 m0, s7, 87040
  s_add_u32 s67, s6, 40960
  buffer_load_dwordx4 v202, s[56:59], s67 offen  lds
  s_add_u32 m0, s7, 88064
  s_add_u32 s67, s6, 49152
  buffer_load_dwordx4 v202, s[56:59], s67 offen  lds
  s_add_u32 m0, s7, 89088
  s_add_u32 s67, s6, 57344
  buffer_load_dwordx4 v202, s[56:59], s67 offen  lds
  s_add_u32 m0, s7, 114688
  s_add_u32 s67, s6, 262144
  buffer_load_dwordx4 v202, s[56:59], s67 offen  lds
  s_add_u32 m0, s7, 115712
  s_add_u32 s67, s6, 270336
  buffer_load_dwordx4 v202, s[56:59], s67 offen  lds
  s_add_u32 m0, s7, 116736
  s_add_u32 s67, s6, 278528
  buffer_load_dwordx4 v202, s[56:59], s67 offen  lds
  s_add_u32 m0, s7, 117760
  s_add_u32 s67, s6, 286720
  buffer_load_dwordx4 v202, s[56:59], s67 offen  lds
  s_add_u32 m0, s7, 118784
  s_add_u32 s67, s6, 294912
  buffer_load_dwordx4 v202, s[56:59], s67 offen  lds
  s_add_u32 m0, s7, 119808
  s_add_u32 s67, s6, 303104
  buffer_load_dwordx4 v202, s[56:59], s67 offen  lds
  s_add_u32 m0, s7, 120832
  s_add_u32 s67, s6, 311296
  buffer_load_dwordx4 v202, s[56:59], s67 offen  lds
  s_add_u32 m0, s7, 121856
  s_add_u32 s67, s6, 319488
  buffer_load_dwordx4 v202, s[56:59], s67 offen  lds
L_st_nowo7:
  s_cmp_lg_u32 s61, 0
  s_cbranch_scc1 L_a2_p2done
  global_load_dword v165, v196, s[38:39] sc1
  s_branch L_a2_p2done
L_st_p2_6:
  s_waitcnt lgkmcnt(0)
  s_nop 1
  v_mfma_f32_32x32x16_bf16 v[136:151], v[128:131], v[112:115], v[136:151]
  v_mfma_f32_32x32x16_bf16 v[136:151], v[132:135], v[116:119], v[136:151]
  s_cmp_ge_u32 s61, 4
  s_cbranch_scc1 L_st_nowo6
  s_add_u32 m0, s7, 86016
  s_add_u32 s67, s6, 32768
  buffer_load_dwordx4 v202, s[56:59], s67 offen  lds
  s_add_u32 m0, s7, 87040
  s_add_u32 s67, s6, 40960
  buffer_load_dwordx4 v202, s[56:59], s67 offen  lds
  s_add_u32 m0, s7, 88064
  s_add_u32 s67, s6, 49152
  buffer_load_dwordx4 v202, s[56:59], s67 offen  lds
  s_add_u32 m0, s7, 89088
  s_add_u32 s67, s6, 57344
  buffer_load_dwordx4 v202, s[56:59], s67 offen  lds
  s_add_u32 m0, s7, 114688
  s_add_u32 s67, s6, 262144
  buffer_load_dwordx4 v202, s[56:59], s67 offen  lds
  s_add_u32 m0, s7, 115712
  s_add_u32 s67, s6, 270336
  buffer_load_dwordx4 v202, s[56:59], s67 offen  lds
  s_add_u32 m0, s7, 116736
  s_add_u32 s67, s6, 278528
  buffer_load_dwordx4 v202, s[56:59], s67 offen  lds
  s_add_u32 m0, s7, 117760
  s_add_u32 s67, s6, 286720
  buffer_load_dwordx4 v202, s[56:59], s67 offen  lds
  s_add_u32 m0, s7, 118784
  s_add_u32 s67, s6, 294912
  buffer_load_dwordx4 v202, s[56:59], s67 offen  lds
  s_add_u32 m0, s7, 119808
  s_add_u32 s67, s6, 303104
  buffer_load_dwordx4 v202, s[56:59], s67 offen  lds
  s_add_u32 m0, s7, 120832
  s_add_u32 s67, s6, 311296
  buffer_load_dwordx4 v202, s[56:59], s67 offen  lds
  s_add_u32 m0, s7, 121856
  s_add_u32 s67, s6, 319488
  buffer_load_dwordx4 v202, s[56:59], s67 offen  lds
L_st_nowo6:
  s_cmp_lg_u32 s61, 0
  s_cbranch_scc1 L_a2_p2done
  global_load_dword v165, v196, s[38:39] sc1
  s_branch L_a2_p2done
L_st_p2_5:
  s_waitcnt lgkmcnt(0)
  s_nop 1
  v_mfma_f32_32x32x16_bf16 v[136:151], v[120:123], v[104:107], v[136:151]
  v_mfma_f32_32x32x16_bf16 v[136:151], v[124:127], v[108:111], v[136:151]
  s_cmp_ge_u32 s61, 4
  s_cbranch_scc1 L_st_nowo5
  s_add_u32 m0, s7, 114688
  s_add_u32 s67, s6, 262144
  buffer_load_dwordx4 v202, s[56:59], s67 offen  lds
  s_add_u32 m0, s7, 115712
  s_add_u32 s67, s6, 270336
  buffer_load_dwordx4 v202, s[56:59], s67 offen  lds
  s_add_u32 m0, s7, 116736
  s_add_u32 s67, s6, 278528
  buffer_load_dwordx4 v202, s[56:59], s67 offen  lds
  s_add_u32 m0, s7, 117760
  s_add_u32 s67, s6, 286720
  buffer_load_dwordx4 v202, s[56:59], s67 offen  lds
  s_add_u32 m0, s7, 118784
  s_add_u32 s67, s6, 294912
  buffer_load_dwordx4 v202, s[56:59], s67 offen  lds
  s_add_u32 m0, s7, 119808
  s_add_u32 s67, s6, 303104
  buffer_load_dwordx4 v202, s[56:59], s67 offen  lds
  s_add_u32 m0, s7, 120832
  s_add_u32 s67, s6, 311296
  buffer_load_dwordx4 v202, s[56:59], s67 offen  lds
  s_add_u32 m0, s7, 121856
  s_add_u32 s67, s6, 319488
  buffer_load_dwordx4 v202, s[56:59], s67 offen  lds
L_st_nowo5:
  s_cmp_lg_u32 s61, 0
  s_cbranch_scc1 L_a2_p2done
  global_load_dword v165, v196, s[38:39] sc1
  s_branch L_a2_p2done
L_st_p2_4:
  s_waitcnt lgkmcnt(0)
  s_nop 1
  v_mfma_f32_32x32x16_bf16 v[136:151], v[128:131], v[112:115], v[136:151]
  v_mfma_f32_32x32x16_bf16 v[136:151], v[132:135], v[116:119], v[136:151]
  s_cmp_ge_u32 s61, 4
  s_cbranch_scc1 L_st_nowo4
  s_add_u32 m0, s7, 118784
  s_add_u32 s67, s6, 294912
  buffer_load_dwordx4 v202, s[56:59], s67 offen  lds
  s_add_u32 m0, s7, 119808
  s_add_u32 s67, s6, 303104
  buffer_load_dwordx4 v202, s[56:59], s67 offen  lds
  s_add_u32 m0, s7, 120832
  s_add_u32 s67, s6, 311296
  buffer_load_dwordx4 v202, s[56:59], s67 offen  lds
  s_add_u32 m0, s7, 121856
  s_add_u32 s67, s6, 319488
  buffer_load_dwordx4 v202, s[56:59], s67 offen  lds
L_st_nowo4:
  s_cmp_lg_u32 s61, 0
  s_cbranch_scc1 L_a2_p2done
  global_load_dword v165, v196, s[38:39] sc1
  s_branch L_a2_p2done
L_st_p2_3:
  s_waitcnt lgkmcnt(0)
  s_nop 1
  v_mfma_f32_32x32x16_bf16 v[136:151], v[120:123], v[104:107], v[136:151]
  v_mfma_f32_32x32x16_bf16 v[136:151], v[124:127], v[108:111], v[136:151]
  s_cmp_lg_u32 s61, 0
  s_cbranch_scc1 L_a2_p2done
  global_load_dword v165, v196, s[38:39] sc1
  s_branch L_a2_p2done
L_st_p2_2:
  s_waitcnt lgkmcnt(0)
  s_nop 1
  v_mfma_f32_32x32x16_bf16 v[136:151], v[128:131], v[112:115], v[136:151]
  v_mfma_f32_32x32x16_bf16 v[136:151], v[132:135], v[116:119], v[136:151]
  s_branch L_a2_p2done
L_st_p2_1:
  s_waitcnt lgkmcnt(0)
  s_nop 1
  v_mfma_f32_32x32x16_bf16 v[136:151], v[120:123], v[104:107], v[136:151]
  v_mfma_f32_32x32x16_bf16 v[136:151], v[124:127], v[108:111], v[136:151]
  s_branch L_a2_p2done
.section .rodata,"a"
.p2align 6
.amdhsa_kernel concat_heads__sliding_block__ssm_conv_h3__prompt_kernel
  .amdhsa_next_free_vgpr 256
  .amdhsa_next_free_sgpr 102
  .amdhsa_accum_offset 256
  .amdhsa_group_segment_fixed_size 0
  .amdhsa_kernarg_size 96
  .amdhsa_user_sgpr_count 2
  .amdhsa_user_sgpr_kernarg_segment_ptr 1
  .amdhsa_system_sgpr_workgroup_id_x 1
.end_amdhsa_kernel
```
